```python
import torch

def _softmax(x, axis=-1):
    return torch.softmax(x, dim=axis)
def _gelu(x):
    return torch.nn.functional.gelu(x, approximate="tanh")
def _silu(x):
    return torch.nn.functional.silu(x)
def _sigmoid(x):
    return torch.sigmoid(x)
def _layernorm(x, axis=-1, eps=1e-5):
    m = x.mean(dim=axis, keepdim=True)
    v = x.var(dim=axis, keepdim=True, unbiased=False)
    return (x - m) / torch.sqrt(v + eps)
def _scatter_add(tgt, idx, src, axis=0):
    return tgt.clone().index_add_(axis, idx, src)
def _segment_sum(src, seg, n):
    out = torch.zeros((n,) + src.shape[1:], dtype=src.dtype)
    return out.index_add_(0, seg, src)
def _pad(x, pw):
    flat = tuple(v for pair in reversed(pw) for v in pair)
    return torch.nn.functional.pad(x, flat)

kernel_name = 'sequential_preLN__ssm_conv_s4d__geglu_ffn__prompt'

def setup_inputs():

    _w = (lambda a: (lambda t: t.to(torch.bfloat16) if t.is_floating_point() else t)(torch.as_tensor(a)))
    def _A_setup():
        Bsz, L, D, N = 1, 2048, 1024, 128
        return {
            "u": _w((lambda *s: torch.randn(*s, dtype=torch.bfloat16) * 0.05)(Bsz, L, D)),
            "log_A_real": _w((lambda *s: torch.randn(*s, dtype=torch.bfloat16) * 6.4)(D, N) * 0.5),
            "A_imag": _w((lambda *s: torch.randn(*s, dtype=torch.bfloat16) * 0.05)(D, N) * 3.14),
            "C_real": _w((lambda *s: torch.randn(*s, dtype=torch.bfloat16) * 0.05)(D, N) / N ** 0.5),
            "C_imag": _w((lambda *s: torch.randn(*s, dtype=torch.bfloat16) * 0.05)(D, N) / N ** 0.5),
            "log_dt": _w((lambda *s: torch.randn(*s, dtype=torch.bfloat16) * 0.05)(D) * 0.5 - 4.0),
            "D_skip": _w((lambda *s: torch.randn(*s, dtype=torch.bfloat16) * 0.05)(D)),
        }
    _A_in = _A_setup()

    def _B_setup():
        B, S, D, F = 1, 2048, 1024, 3584
        return {
            "x": _w((lambda *s: torch.randn(*s, dtype=torch.bfloat16) * 0.05)(B, S, D)),
            "w_gate": _w((lambda *s: torch.randn(*s, dtype=torch.bfloat16) * 0.05)(D, F)),
            "w_up": _w((lambda *s: torch.randn(*s, dtype=torch.bfloat16) * 0.05)(D, F)),
            "w_down": _w((lambda *s: torch.randn(*s, dtype=torch.bfloat16) * 0.05)(F, D)),
        }
    _B_in = _B_setup()

    return {
        "A_u": _A_in["u"],
        "A_log_A_real": _A_in["log_A_real"],
        "A_A_imag": _A_in["A_imag"],
        "A_C_real": _A_in["C_real"],
        "A_C_imag": _A_in["C_imag"],
        "A_log_dt": _A_in["log_dt"],
        "A_D_skip": _A_in["D_skip"],
        "B_x": _B_in["x"],
        "B_w_gate": _B_in["w_gate"],
        "B_w_up": _B_in["w_up"],
        "B_w_down": _B_in["w_down"],
    }

def reference(A_u, A_log_A_real, A_A_imag, A_C_real, A_C_imag, A_log_dt, A_D_skip, B_x, B_w_gate, B_w_up, B_w_down):
    def _A_ref(u, log_A_real, A_imag, C_real, C_imag, log_dt, D_skip):
        L = u.shape[1]
        dt = torch.exp(log_dt)
        A = -torch.exp(log_A_real) + 1j * A_imag
        C = (C_real + 1j * C_imag) * dt[:, None]
        pos = (lambda x, dt: x.to(dt))(torch.arange(L), log_dt.dtype)
        P = torch.exp((A * dt[:, None])[:, :, None] * pos[None, None, :])
        K = 2.0 * torch.einsum("dn,dnl->dl", C, P).real
        L2 = 2 * L
        u_t = (lambda x, *d: x.permute(*d))(u, 0, 2, 1)
        Kf = (lambda x, *a, **k: torch.fft.rfft(x.float(), *a, **k))(K, L2)
        Uf = (lambda x, *a, **k: torch.fft.rfft(x.float(), *a, **k))(u_t, L2)
        y = (lambda x, *a, **k: torch.fft.irfft(x, *a, **k).to(torch.bfloat16))(Uf * Kf[None, :, :], L2)[:, :, :L]
        y = (lambda x, *d: x.permute(*d))(y, 0, 2, 1)
        return y + u * D_skip[None, None, :]

    def _B_ref(x, w_gate, w_up, w_down):
        return (_gelu(x @ w_gate) * (x @ w_up)) @ w_down

    x = A_u
    h = x + _A_ref(_layernorm(x, axis=-1), A_log_A_real, A_A_imag, A_C_real, A_C_imag, A_log_dt, A_D_skip)
    h2 = h + _B_ref(_layernorm(h, axis=-1), B_w_gate, B_w_up, B_w_down)
    return h2
```

```asm
; @launch grid=(256,1,1) block=(512,1,1) lds=149696
.amdgcn_target "amdgcn-amd-amdhsa--gfx950"
.text
.globl sequential_preLN__ssm_conv_s4d__geglu_ffn__prompt_kernel
.p2align 8
.type sequential_preLN__ssm_conv_s4d__geglu_ffn__prompt_kernel,@function
sequential_preLN__ssm_conv_s4d__geglu_ffn__prompt_kernel:
    s_cmp_ge_u32 s2, 256
    s_cbranch_scc1 L_k2_exit
    s_load_dwordx8 s[64:71], s[0:1], 8
    s_load_dwordx2 s[18:19], s[0:1], 0
    s_load_dwordx4 s[72:75], s[0:1], 40
    s_load_dwordx4 s[8:11], s[0:1], 64
    s_load_dwordx4 s[12:15], s[0:1], 96
    s_getpc_b64 s[56:57]
L_k2_pc:
    s_mov_b32 s58, code_end-L_k2_pc
    s_mov_b32 s59, 0x00020000
    v_and_b32 v11, 15, v0
    v_lshlrev_b32 v11, 7, v11
    s_lshr_b32 s46, s2, 3
    s_lshl_b32 s45, s46, 11
    v_lshrrev_b32 v1, 6, v0
    v_and_b32 v14, 63, v0
    v_readfirstlane_b32 s30, v1
    s_mov_b32 s47, 0xffff0000
    s_and_b32 s31, s2, 7
    s_lshl_b32 s31, s31, 5
    s_lshr_b32 s3, s2, 3
    s_add_u32 s3, s3, s31
    s_lshr_b32 s29, s3, 1
    s_and_b32 s28, s3, 1
    s_and_b32 s27, s30, 3
    s_lshl_b32 s32, s3, 2
    s_add_u32 s32, s32, s27
    s_lshl_b32 s33, s32, 8
    v_lshl_add_u32 v2, v14, 2, s33
    s_lshl_b32 s34, s3, 3
    s_lshl_b32 s25, s2, 3
    s_add_u32 s25, s25, s30
    s_lshl_b32 s24, s25, 11
    v_lshlrev_b32 v13, 4, v14
    s_waitcnt lgkmcnt(0)
    s_mov_b32 s16, s14
    s_mov_b32 s17, s15
    s_load_dwordx2 s[4:5], s[72:73], s34
    s_load_dwordx2 s[6:7], s[74:75], s34
    s_mov_b32 s35, 0x01738000
    s_load_dword s13, s[16:17], s35
    s_mov_b32 s20, s18
    s_mov_b32 s21, s19
    s_mov_b32 s22, 0x00400000
    s_mov_b32 s23, 0x00020000
    s_mov_b32 s36, s64
    s_mov_b32 s37, s65
    s_mov_b32 s38, 0x00040000
    s_mov_b32 s39, 0x00020000
    buffer_load_dword v4, v2, s[36:39], 0 offen
    s_mov_b32 s40, s66
    s_mov_b32 s41, s67
    s_mov_b32 s42, 0x00040000
    s_mov_b32 s43, 0x00020000
    buffer_load_dword v5, v2, s[40:43], 0 offen
    s_mov_b32 s48, s68
    s_mov_b32 s49, s69
    s_mov_b32 s50, 0x00040000
    s_mov_b32 s51, 0x00020000
    buffer_load_dword v6, v2, s[48:51], 0 offen
    s_mov_b32 s52, s70
    s_mov_b32 s53, s71
    s_mov_b32 s54, 0x00040000
    s_mov_b32 s55, 0x00020000
    buffer_load_dword v7, v2, s[52:55], 0 offen
    buffer_load_dwordx4 v[96:99], v13, s[20:23], s24 offen
    buffer_load_dwordx4 v[100:103], v13, s[20:23], s24 offen offset:1024
    s_add_u32 s76, s16, 0x01730000
    s_addc_u32 s77, s17, 0
    s_mov_b32 s78, 0x00004000
    s_mov_b32 s79, 0x00020000
    v_and_b32 v152, 60, v14
    v_and_b32 v153, 3, v14
    v_lshl_add_u32 v152, v152, 1, v153
    s_lshl_b32 s35, s30, 8
    v_add_u32 v152, s35, v152
    v_lshlrev_b32 v154, 3, v152
    s_lshl_b32 s44, s30, 11
    v_add_u32 v154, s44, v13
    v_lshl_add_u32 v155, v152, 11, s34
    v_lshlrev_b32 v3, 3, v14
    s_sub_u32 s35, s35, 4
    v_add_u32 v157, s35, v153
    v_lshlrev_b32 v205, 3, v157
    v_lshl_add_u32 v157, v157, 11, s34
    s_mov_b32 s80, 0
    s_mov_b32 s81, 8192
    s_mov_b32 s82, 262144
    s_mov_b32 s83, 270336
    buffer_load_dwordx2 v[170:171], v157, s[20:23], 0 offen
    buffer_load_dword v204, v11, s[56:59], s45 offen
    s_add_u32 s56, s16, 0x01730000
    s_addc_u32 s57, s17, 0
    s_mov_b32 s58, 0x00030000
    s_mov_b32 s59, 0x00020000
    s_lshl_b32 s44, s25, 4
    s_add_u32 s44, s44, 65536
    v_mov_b32 v108, s44
    v_mov_b32 v104, -1
    v_mov_b32 v105, -1
    v_mov_b32 v106, -1
    v_mov_b32 v107, -1
    s_mov_b64 exec, 1
    buffer_store_dwordx4 v[104:107], v108, s[56:59], 0 offen sc1
    s_mov_b64 exec, -1
    s_barrier
    s_cmp_ge_u32 s30, 4
    s_cbranch_scc1 L_k2_g0
    buffer_load_dwordx2 v[196:197], v155, s[20:23], s80 offen
L_k2_g0:
    s_mul_i32 s34, s27, 31008
    v_add_u32 v9, s34, v3
    v_and_b32 v10, 15, v14
    v_lshrrev_b32 v11, 4, v14
    v_mul_u32_u24 v12, 544, v10
    v_lshl_add_u32 v12, v11, 4, v12
    v_add_u32 v12, s34, v12
    s_waitcnt lgkmcnt(0)
    s_cmp_ge_u32 s27, 2
    s_cselect_b32 s33, s5, s4
    s_lshl_b32 s35, s33, 16
    s_and_b32 s33, s33, s47
    s_bitcmp1_b32 s27, 0
    s_cselect_b32 s33, s33, s35
    v_mov_b32 v8, s33
    v_mul_f32 v8, 0x3fb8aa3b, v8
    v_exp_f32 v8, v8
    s_cmp_ge_u32 s27, 2
    s_cselect_b32 s33, s7, s6
    s_lshl_b32 s35, s33, 16
    s_and_b32 s33, s33, s47
    s_bitcmp1_b32 s27, 0
    s_cselect_b32 s26, s33, s35
    s_mul_i32 s13, s13, 0x9e3779b1
    s_add_u32 s13, s13, 0x7f4a7c15
    s_cmp_ge_u32 s30, 4
    s_waitcnt vmcnt(6)
    s_cbranch_scc0 L_k2_g1
    s_waitcnt vmcnt(5)
L_k2_g1:
    v_lshlrev_b32 v16, 16, v4
    v_and_b32 v17, s47, v4
    v_mul_f32 v16, 0x3fb8aa3b, v16
    v_mul_f32 v17, 0x3fb8aa3b, v17
    v_cvt_pk_bf16_f32 v8, v8, v8
    v_exp_f32 v16, v16
    v_exp_f32 v17, v17
    v_lshlrev_b32 v18, 16, v5
    v_and_b32 v19, s47, v5
    v_and_b32 v8, s47, v8
    v_cvt_pk_bf16_f32 v16, v16, v17
    v_mul_f32 v18, v18, v8
    v_mul_f32 v19, v19, v8
    v_and_b32 v17, s47, v16
    v_lshlrev_b32 v16, 16, v16
    v_mul_f32 v18, 0.15915494, v18
    v_mul_f32 v19, 0.15915494, v19
    v_mul_f32 v16, v16, v8
    v_mul_f32 v17, v17, v8
    v_lshlrev_b32 v20, 16, v6
    v_and_b32 v21, s47, v6
    v_mul_f32 v16, 0xbfb8aa3b, v16
    v_mul_f32 v17, 0xbfb8aa3b, v17
    v_lshlrev_b32 v22, 16, v7
    v_and_b32 v23, s47, v7
    v_mul_f32 v42, 0x43000000, v18
    v_mul_f32 v43, 0x43000000, v19
    v_mul_f32 v40, 0x43000000, v16
    v_mul_f32 v41, 0x43000000, v17
    v_fract_f32 v42, v42
    v_fract_f32 v43, v43
    v_exp_f32 v40, v40
    v_exp_f32 v41, v41
    v_cos_f32 v24, v42
    v_cos_f32 v25, v43
    v_sin_f32 v26, v42
    v_sin_f32 v27, v43
    v_pk_mul_f32 v[24:25], v[24:25], v[40:41]
    v_pk_mul_f32 v[26:27], v[26:27], v[40:41]
    s_cmp_ge_u32 s30, 4
    s_waitcnt vmcnt(4)
    s_cbranch_scc0 L_k2_g5
    s_waitcnt vmcnt(3)
    buffer_load_dwordx2 v[196:197], v155, s[20:23], s80 offen
L_k2_g5:
    v_lshlrev_b32 v104, 16, v96
    v_and_b32 v105, s47, v96
    v_lshlrev_b32 v106, 16, v97
    v_and_b32 v107, s47, v97
    v_lshlrev_b32 v108, 16, v98
    v_and_b32 v109, s47, v98
    v_lshlrev_b32 v110, 16, v99
    v_and_b32 v111, s47, v99
    v_lshlrev_b32 v112, 16, v100
    v_and_b32 v113, s47, v100
    v_lshlrev_b32 v114, 16, v101
    v_and_b32 v115, s47, v101
    v_lshlrev_b32 v116, 16, v102
    v_and_b32 v117, s47, v102
    v_lshlrev_b32 v118, 16, v103
    v_and_b32 v119, s47, v103
    v_pk_add_f32 v[120:121], v[104:105], v[106:107]
    v_pk_add_f32 v[122:123], v[108:109], v[110:111]
    v_pk_add_f32 v[124:125], v[112:113], v[114:115]
    v_pk_add_f32 v[126:127], v[116:117], v[118:119]
    v_pk_add_f32 v[120:121], v[120:121], v[122:123]
    v_pk_add_f32 v[124:125], v[124:125], v[126:127]
    v_pk_add_f32 v[120:121], v[120:121], v[124:125]
    v_add_f32 v120, v120, v121
    s_nop 1
    v_add_f32_dpp v120, v120, v120 quad_perm:[1,0,3,2] row_mask:0xf bank_mask:0xf
    s_nop 1
    v_add_f32_dpp v120, v120, v120 quad_perm:[2,3,0,1] row_mask:0xf bank_mask:0xf
    s_nop 1
    v_add_f32_dpp v120, v120, v120 row_half_mirror row_mask:0xf bank_mask:0xf
    s_nop 1
    v_add_f32_dpp v120, v120, v120 row_mirror row_mask:0xf bank_mask:0xf
    v_mov_b32 v121, v120
    s_nop 1
    v_permlane16_swap_b32 v120, v121
    v_add_f32 v120, v120, v121
    v_mov_b32 v121, v120
    s_nop 1
    v_permlane32_swap_b32 v120, v121
    v_add_f32 v120, v120, v121
    v_mul_f32 v120, 0x3a800000, v120
    v_pk_add_f32 v[104:105], v[104:105], v[120:121] op_sel_hi:[1,0] neg_lo:[0,1] neg_hi:[0,1]
    v_pk_add_f32 v[106:107], v[106:107], v[120:121] op_sel_hi:[1,0] neg_lo:[0,1] neg_hi:[0,1]
    v_pk_add_f32 v[108:109], v[108:109], v[120:121] op_sel_hi:[1,0] neg_lo:[0,1] neg_hi:[0,1]
    v_pk_add_f32 v[110:111], v[110:111], v[120:121] op_sel_hi:[1,0] neg_lo:[0,1] neg_hi:[0,1]
    v_pk_add_f32 v[112:113], v[112:113], v[120:121] op_sel_hi:[1,0] neg_lo:[0,1] neg_hi:[0,1]
    v_pk_add_f32 v[114:115], v[114:115], v[120:121] op_sel_hi:[1,0] neg_lo:[0,1] neg_hi:[0,1]
    v_pk_add_f32 v[116:117], v[116:117], v[120:121] op_sel_hi:[1,0] neg_lo:[0,1] neg_hi:[0,1]
    v_pk_add_f32 v[118:119], v[118:119], v[120:121] op_sel_hi:[1,0] neg_lo:[0,1] neg_hi:[0,1]
    v_pk_mul_f32 v[122:123], v[104:105], v[104:105]
    v_pk_mul_f32 v[124:125], v[106:107], v[106:107]
    v_pk_fma_f32 v[122:123], v[108:109], v[108:109], v[122:123]
    v_pk_fma_f32 v[124:125], v[110:111], v[110:111], v[124:125]
    v_pk_fma_f32 v[122:123], v[112:113], v[112:113], v[122:123]
    v_pk_fma_f32 v[124:125], v[114:115], v[114:115], v[124:125]
    v_pk_fma_f32 v[122:123], v[116:117], v[116:117], v[122:123]
    v_pk_fma_f32 v[124:125], v[118:119], v[118:119], v[124:125]
    v_pk_add_f32 v[122:123], v[122:123], v[124:125]
    v_add_f32 v122, v122, v123
    s_nop 1
    v_add_f32_dpp v122, v122, v122 quad_perm:[1,0,3,2] row_mask:0xf bank_mask:0xf
    s_nop 1
    v_add_f32_dpp v122, v122, v122 quad_perm:[2,3,0,1] row_mask:0xf bank_mask:0xf
    s_nop 1
    v_add_f32_dpp v122, v122, v122 row_half_mirror row_mask:0xf bank_mask:0xf
    s_nop 1
    v_add_f32_dpp v122, v122, v122 row_mirror row_mask:0xf bank_mask:0xf
    v_mov_b32 v123, v122
    s_nop 1
    v_permlane16_swap_b32 v122, v123
    v_add_f32 v122, v122, v123
    v_mov_b32 v123, v122
    s_nop 1
    v_permlane32_swap_b32 v122, v123
    v_add_f32 v122, v122, v123
    v_mul_f32 v122, 0x3a800000, v122
    v_cvt_pk_bf16_f32 v120, v120, v122
    v_and_b32 v122, s47, v120
    v_lshlrev_b32 v120, 16, v120
    v_add_f32 v122, 0x3727c5ac, v122
    v_cvt_pk_bf16_f32 v122, v122, v122
    v_and_b32 v122, s47, v122
    v_sqrt_f32 v122, v122
    s_lshl_b32 s44, s25, 3
    v_cvt_pk_bf16_f32 v122, v120, v122
    v_mov_b32 v123, s13
    s_lshl3_add_u32 s44, s30, 149632
    v_mov_b32 v124, s44
    ds_write_b64 v124, v[122:123]
    s_cmp_ge_u32 s30, 4
    s_cbranch_scc1 L_k2_halfB
    buffer_load_dwordx2 v[198:199], v155, s[20:23], s81 offen
    v_mul_f32 v42, 0x41000000, v18
    v_mul_f32 v43, 0x41000000, v19
    v_mul_f32 v40, 0x41000000, v16
    v_mul_f32 v41, 0x41000000, v17
    v_fract_f32 v42, v42
    v_fract_f32 v43, v43
    v_exp_f32 v40, v40
    v_exp_f32 v41, v41
    v_cos_f32 v28, v42
    v_cos_f32 v29, v43
    v_sin_f32 v30, v42
    v_sin_f32 v31, v43
    v_pk_mul_f32 v[28:29], v[28:29], v[40:41]
    v_pk_mul_f32 v[30:31], v[30:31], v[40:41]
    v_fract_f32 v46, v18
    v_fract_f32 v47, v19
    v_exp_f32 v44, v16
    v_exp_f32 v45, v17
    v_cos_f32 v32, v46
    v_cos_f32 v33, v47
    v_sin_f32 v34, v46
    v_sin_f32 v35, v47
    v_pk_mul_f32 v[32:33], v[32:33], v[44:45]
    v_pk_mul_f32 v[34:35], v[34:35], v[44:45]
    v_mov_b32 v118, 0x00003f80
    v_mov_b32 v119, 0x00003f80
    ds_write_b64 v9, v[118:119] offset:22304
    v_cvt_pk_bf16_f32 v120, v28, -v30
    v_cvt_pk_bf16_f32 v121, v29, -v31
    ds_write_b64 v9, v[120:121] offset:22848
    s_waitcnt vmcnt(2) lgkmcnt(0)
    s_barrier
    v_pk_mul_f32 v[48:49], v[28:29], v[28:29]
    v_pk_mul_f32 v[36:37], v[32:33], v[32:33]
    v_pk_mul_f32 v[50:51], v[28:29], v[30:31]
    v_pk_mul_f32 v[38:39], v[32:33], v[34:35]
    v_pk_fma_f32 v[48:49], v[30:31], v[30:31], v[48:49] neg_lo:[1,0,0] neg_hi:[1,0,0]
    v_pk_fma_f32 v[36:37], v[34:35], v[34:35], v[36:37] neg_lo:[1,0,0] neg_hi:[1,0,0]
    v_pk_fma_f32 v[50:51], v[30:31], v[28:29], v[50:51]
    v_pk_fma_f32 v[38:39], v[34:35], v[32:33], v[38:39]
    v_cvt_pk_bf16_f32 v122, v48, -v50
    v_cvt_pk_bf16_f32 v123, v49, -v51
    ds_write_b64 v9, v[122:123] offset:23392
    v_pk_mul_f32 v[52:53], v[48:49], v[28:29]
    v_pk_mul_f32 v[56:57], v[20:21], v[32:33]
    v_pk_mul_f32 v[54:55], v[48:49], v[30:31]
    v_pk_mul_f32 v[58:59], v[20:21], v[34:35]
    v_pk_fma_f32 v[52:53], v[50:51], v[30:31], v[52:53] neg_lo:[1,0,0] neg_hi:[1,0,0]
    v_pk_fma_f32 v[56:57], v[22:23], v[34:35], v[56:57] neg_lo:[1,0,0] neg_hi:[1,0,0]
    v_pk_fma_f32 v[54:55], v[50:51], v[28:29], v[54:55]
    v_pk_fma_f32 v[58:59], v[22:23], v[32:33], v[58:59]
    v_cvt_pk_bf16_f32 v124, v52, -v54
    v_cvt_pk_bf16_f32 v126, v56, v58
    v_cvt_pk_bf16_f32 v125, v53, -v55
    v_cvt_pk_bf16_f32 v127, v57, v59
    ds_write_b64 v9, v[124:125] offset:23936
    ds_write_b64 v9, v[126:127] offset:544
    v_pk_mul_f32 v[48:49], v[52:53], v[28:29]
    v_pk_mul_f32 v[60:61], v[56:57], v[36:37]
    v_pk_mul_f32 v[50:51], v[52:53], v[30:31]
    v_pk_mul_f32 v[62:63], v[56:57], v[38:39]
    v_pk_fma_f32 v[48:49], v[54:55], v[30:31], v[48:49] neg_lo:[1,0,0] neg_hi:[1,0,0]
    v_pk_fma_f32 v[60:61], v[58:59], v[38:39], v[60:61] neg_lo:[1,0,0] neg_hi:[1,0,0]
    v_pk_fma_f32 v[50:51], v[54:55], v[28:29], v[50:51]
    v_pk_fma_f32 v[62:63], v[58:59], v[36:37], v[62:63]
    v_cvt_pk_bf16_f32 v128, v48, -v50
    v_cvt_pk_bf16_f32 v130, v60, v62
    v_cvt_pk_bf16_f32 v129, v49, -v51
    v_cvt_pk_bf16_f32 v131, v61, v63
    ds_write_b64 v9, v[128:129] offset:24480
    ds_write_b64 v9, v[130:131] offset:1632
    buffer_load_dwordx2 v[200:201], v155, s[20:23], s82 offen
    v_pk_mul_f32 v[52:53], v[48:49], v[28:29]
    v_pk_mul_f32 v[64:65], v[60:61], v[36:37]
    v_pk_mul_f32 v[54:55], v[48:49], v[30:31]
    v_pk_mul_f32 v[66:67], v[60:61], v[38:39]
    v_pk_fma_f32 v[52:53], v[50:51], v[30:31], v[52:53] neg_lo:[1,0,0] neg_hi:[1,0,0]
    v_pk_fma_f32 v[64:65], v[62:63], v[38:39], v[64:65] neg_lo:[1,0,0] neg_hi:[1,0,0]
    v_pk_fma_f32 v[54:55], v[50:51], v[28:29], v[54:55]
    v_pk_fma_f32 v[66:67], v[62:63], v[36:37], v[66:67]
    v_cvt_pk_bf16_f32 v132, v52, -v54
    v_cvt_pk_bf16_f32 v134, v64, v66
    v_cvt_pk_bf16_f32 v133, v53, -v55
    v_cvt_pk_bf16_f32 v135, v65, v67
    ds_write_b64 v9, v[132:133] offset:25024
    ds_write_b64 v9, v[134:135] offset:2720
    v_pk_mul_f32 v[48:49], v[52:53], v[28:29]
    v_pk_mul_f32 v[72:73], v[64:65], v[32:33]
    v_pk_mul_f32 v[50:51], v[52:53], v[30:31]
    v_pk_mul_f32 v[74:75], v[64:65], v[34:35]
    v_pk_fma_f32 v[48:49], v[54:55], v[30:31], v[48:49] neg_lo:[1,0,0] neg_hi:[1,0,0]
    v_pk_fma_f32 v[72:73], v[66:67], v[34:35], v[72:73] neg_lo:[1,0,0] neg_hi:[1,0,0]
    v_pk_fma_f32 v[50:51], v[54:55], v[28:29], v[50:51]
    v_pk_fma_f32 v[74:75], v[66:67], v[32:33], v[74:75]
    v_cvt_pk_bf16_f32 v120, v48, -v50
    v_cvt_pk_bf16_f32 v122, v72, v74
    v_cvt_pk_bf16_f32 v121, v49, -v51
    v_cvt_pk_bf16_f32 v123, v73, v75
    ds_write_b64 v9, v[120:121] offset:25568
    ds_write_b64 v9, v[122:123] offset:3264
    v_pk_mul_f32 v[52:53], v[48:49], v[28:29]
    v_pk_mul_f32 v[68:69], v[64:65], v[36:37]
    v_pk_mul_f32 v[54:55], v[48:49], v[30:31]
    v_pk_mul_f32 v[70:71], v[64:65], v[38:39]
    v_pk_fma_f32 v[52:53], v[50:51], v[30:31], v[52:53] neg_lo:[1,0,0] neg_hi:[1,0,0]
    v_pk_fma_f32 v[68:69], v[66:67], v[38:39], v[68:69] neg_lo:[1,0,0] neg_hi:[1,0,0]
    v_pk_fma_f32 v[54:55], v[50:51], v[28:29], v[54:55]
    v_pk_fma_f32 v[70:71], v[66:67], v[36:37], v[70:71]
    v_cvt_pk_bf16_f32 v124, v52, -v54
    v_cvt_pk_bf16_f32 v126, v68, v70
    v_cvt_pk_bf16_f32 v125, v53, -v55
    v_cvt_pk_bf16_f32 v127, v69, v71
    ds_write_b64 v9, v[124:125] offset:26112
    ds_write_b64 v9, v[126:127] offset:3808
    v_pk_mul_f32 v[48:49], v[52:53], v[28:29]
    v_pk_mul_f32 v[92:93], v[72:73], v[24:25]
    v_pk_mul_f32 v[50:51], v[52:53], v[30:31]
    v_pk_mul_f32 v[94:95], v[72:73], v[26:27]
    v_pk_fma_f32 v[48:49], v[54:55], v[30:31], v[48:49] neg_lo:[1,0,0] neg_hi:[1,0,0]
    v_pk_fma_f32 v[92:93], v[74:75], v[26:27], v[92:93] neg_lo:[1,0,0] neg_hi:[1,0,0]
    v_pk_fma_f32 v[50:51], v[54:55], v[28:29], v[50:51]
    v_pk_fma_f32 v[94:95], v[74:75], v[24:25], v[94:95]
    v_cvt_pk_bf16_f32 v128, v48, -v50
    v_cvt_pk_bf16_f32 v130, v92, v94
    v_cvt_pk_bf16_f32 v129, v49, -v51
    v_cvt_pk_bf16_f32 v131, v93, v95
    ds_write_b64 v9, v[128:129] offset:26656
    ds_write_b64 v9, v[130:131] offset:7616
    buffer_load_dwordx2 v[202:203], v155, s[20:23], s83 offen
    v_pk_mul_f32 v[52:53], v[48:49], v[28:29]
    v_pk_mul_f32 v[76:77], v[56:57], v[24:25]
    v_pk_mul_f32 v[54:55], v[48:49], v[30:31]
    v_pk_mul_f32 v[78:79], v[56:57], v[26:27]
    v_pk_fma_f32 v[52:53], v[50:51], v[30:31], v[52:53] neg_lo:[1,0,0] neg_hi:[1,0,0]
    v_pk_fma_f32 v[76:77], v[58:59], v[26:27], v[76:77] neg_lo:[1,0,0] neg_hi:[1,0,0]
    v_pk_fma_f32 v[54:55], v[50:51], v[28:29], v[54:55]
    v_pk_fma_f32 v[78:79], v[58:59], v[24:25], v[78:79]
    v_cvt_pk_bf16_f32 v132, v52, -v54
    v_cvt_pk_bf16_f32 v134, v76, v78
    v_cvt_pk_bf16_f32 v133, v53, -v55
    v_cvt_pk_bf16_f32 v135, v77, v79
    ds_write_b64 v9, v[132:133] offset:27200
    ds_write_b64 v9, v[134:135] offset:4896
    v_pk_mul_f32 v[48:49], v[52:53], v[28:29]
    v_pk_mul_f32 v[72:73], v[92:93], v[24:25]
    v_pk_mul_f32 v[50:51], v[52:53], v[30:31]
    v_pk_mul_f32 v[74:75], v[92:93], v[26:27]
    v_pk_fma_f32 v[48:49], v[54:55], v[30:31], v[48:49] neg_lo:[1,0,0] neg_hi:[1,0,0]
    v_pk_fma_f32 v[72:73], v[94:95], v[26:27], v[72:73] neg_lo:[1,0,0] neg_hi:[1,0,0]
    v_pk_fma_f32 v[50:51], v[54:55], v[28:29], v[50:51]
    v_pk_fma_f32 v[74:75], v[94:95], v[24:25], v[74:75]
    v_cvt_pk_bf16_f32 v120, v48, -v50
    v_cvt_pk_bf16_f32 v122, v72, v74
    v_cvt_pk_bf16_f32 v121, v49, -v51
    v_cvt_pk_bf16_f32 v123, v73, v75
    ds_write_b64 v9, v[120:121] offset:27744
    ds_write_b64 v9, v[122:123] offset:10336
    v_pk_mul_f32 v[52:53], v[48:49], v[28:29]
    v_pk_mul_f32 v[80:81], v[60:61], v[24:25]
    v_pk_mul_f32 v[54:55], v[48:49], v[30:31]
    v_pk_mul_f32 v[82:83], v[60:61], v[26:27]
    v_pk_fma_f32 v[52:53], v[50:51], v[30:31], v[52:53] neg_lo:[1,0,0] neg_hi:[1,0,0]
    v_pk_fma_f32 v[80:81], v[62:63], v[26:27], v[80:81] neg_lo:[1,0,0] neg_hi:[1,0,0]
    v_pk_fma_f32 v[54:55], v[50:51], v[28:29], v[54:55]
    v_pk_fma_f32 v[82:83], v[62:63], v[24:25], v[82:83]
    v_cvt_pk_bf16_f32 v124, v52, -v54
    v_cvt_pk_bf16_f32 v126, v80, v82
    v_cvt_pk_bf16_f32 v125, v53, -v55
    v_cvt_pk_bf16_f32 v127, v81, v83
    ds_write_b64 v9, v[124:125] offset:28288
    ds_write_b64 v9, v[126:127] offset:5984
    v_pk_mul_f32 v[48:49], v[52:53], v[28:29]
    v_pk_mul_f32 v[92:93], v[72:73], v[24:25]
    v_pk_mul_f32 v[50:51], v[52:53], v[30:31]
    v_pk_mul_f32 v[94:95], v[72:73], v[26:27]
    v_pk_fma_f32 v[48:49], v[54:55], v[30:31], v[48:49] neg_lo:[1,0,0] neg_hi:[1,0,0]
    v_pk_fma_f32 v[92:93], v[74:75], v[26:27], v[92:93] neg_lo:[1,0,0] neg_hi:[1,0,0]
    v_pk_fma_f32 v[50:51], v[54:55], v[28:29], v[50:51]
    v_pk_fma_f32 v[94:95], v[74:75], v[24:25], v[94:95]
    v_cvt_pk_bf16_f32 v128, v48, -v50
    v_cvt_pk_bf16_f32 v130, v92, v94
    v_cvt_pk_bf16_f32 v129, v49, -v51
    v_cvt_pk_bf16_f32 v131, v93, v95
    ds_write_b64 v9, v[128:129] offset:28832
    ds_write_b64 v9, v[130:131] offset:12512
    v_pk_mul_f32 v[52:53], v[48:49], v[28:29]
    v_pk_mul_f32 v[84:85], v[64:65], v[24:25]
    v_pk_mul_f32 v[54:55], v[48:49], v[30:31]
    v_pk_mul_f32 v[86:87], v[64:65], v[26:27]
    v_pk_fma_f32 v[52:53], v[50:51], v[30:31], v[52:53] neg_lo:[1,0,0] neg_hi:[1,0,0]
    v_pk_fma_f32 v[84:85], v[66:67], v[26:27], v[84:85] neg_lo:[1,0,0] neg_hi:[1,0,0]
    v_pk_fma_f32 v[54:55], v[50:51], v[28:29], v[54:55]
    v_pk_fma_f32 v[86:87], v[66:67], v[24:25], v[86:87]
    v_cvt_pk_bf16_f32 v132, v52, -v54
    v_cvt_pk_bf16_f32 v134, v84, v86
    v_cvt_pk_bf16_f32 v133, v53, -v55
    v_cvt_pk_bf16_f32 v135, v85, v87
    ds_write_b64 v9, v[132:133] offset:29376
    ds_write_b64 v9, v[134:135] offset:7072
    v_pk_mul_f32 v[48:49], v[52:53], v[28:29]
    v_pk_mul_f32 v[88:89], v[68:69], v[24:25]
    v_pk_mul_f32 v[50:51], v[52:53], v[30:31]
    v_pk_mul_f32 v[90:91], v[68:69], v[26:27]
    v_pk_fma_f32 v[48:49], v[54:55], v[30:31], v[48:49] neg_lo:[1,0,0] neg_hi:[1,0,0]
    v_pk_fma_f32 v[88:89], v[70:71], v[26:27], v[88:89] neg_lo:[1,0,0] neg_hi:[1,0,0]
    v_pk_fma_f32 v[50:51], v[54:55], v[28:29], v[50:51]
    v_pk_fma_f32 v[90:91], v[70:71], v[24:25], v[90:91]
    v_cvt_pk_bf16_f32 v120, v48, -v50
    v_cvt_pk_bf16_f32 v122, v88, v90
    v_cvt_pk_bf16_f32 v121, v49, -v51
    v_cvt_pk_bf16_f32 v123, v89, v91
    ds_write_b64 v9, v[120:121] offset:29920
    ds_write_b64 v9, v[122:123] offset:8160
    v_pk_mul_f32 v[52:53], v[48:49], v[28:29]
    v_pk_mul_f32 v[54:55], v[48:49], v[30:31]
    v_pk_fma_f32 v[52:53], v[50:51], v[30:31], v[52:53] neg_lo:[1,0,0] neg_hi:[1,0,0]
    v_pk_fma_f32 v[54:55], v[50:51], v[28:29], v[54:55]
    v_cvt_pk_bf16_f32 v124, v52, -v54
    v_cvt_pk_bf16_f32 v125, v53, -v55
    ds_write_b64 v9, v[124:125] offset:30464
    s_branch L_k2_kg2
L_k2_halfB:
    v_mul_f32 v42, 0x40000000, v18
    v_mul_f32 v43, 0x40000000, v19
    v_mul_f32 v40, 0x40000000, v16
    v_mul_f32 v41, 0x40000000, v17
    v_fract_f32 v42, v42
    v_fract_f32 v43, v43
    v_exp_f32 v40, v40
    v_exp_f32 v41, v41
    v_cos_f32 v28, v42
    v_cos_f32 v29, v43
    v_sin_f32 v30, v42
    v_sin_f32 v31, v43
    v_pk_mul_f32 v[28:29], v[28:29], v[40:41]
    v_pk_mul_f32 v[30:31], v[30:31], v[40:41]
    v_cvt_pk_bf16_f32 v126, v20, v22
    v_cvt_pk_bf16_f32 v127, v21, v23
    ds_write_b64 v9, v[126:127] offset:0
    v_pk_mul_f32 v[52:53], v[20:21], v[24:25]
    v_pk_mul_f32 v[56:57], v[20:21], v[28:29]
    v_pk_mul_f32 v[54:55], v[20:21], v[26:27]
    v_pk_mul_f32 v[58:59], v[20:21], v[30:31]
    v_pk_fma_f32 v[52:53], v[22:23], v[26:27], v[52:53] neg_lo:[1,0,0] neg_hi:[1,0,0]
    v_pk_fma_f32 v[56:57], v[22:23], v[30:31], v[56:57] neg_lo:[1,0,0] neg_hi:[1,0,0]
    v_pk_fma_f32 v[54:55], v[22:23], v[24:25], v[54:55]
    v_pk_fma_f32 v[58:59], v[22:23], v[28:29], v[58:59]
    v_cvt_pk_bf16_f32 v128, v52, v54
    v_cvt_pk_bf16_f32 v130, v56, v58
    v_cvt_pk_bf16_f32 v129, v53, v55
    v_cvt_pk_bf16_f32 v131, v57, v59
    ds_write_b64 v9, v[128:129] offset:4352
    ds_write_b64 v9, v[130:131] offset:1088
    buffer_load_dwordx2 v[198:199], v155, s[20:23], s81 offen
    v_pk_mul_f32 v[48:49], v[52:53], v[24:25]
    v_pk_mul_f32 v[64:65], v[56:57], v[28:29]
    v_pk_mul_f32 v[50:51], v[52:53], v[26:27]
    v_pk_mul_f32 v[66:67], v[56:57], v[30:31]
    v_pk_fma_f32 v[48:49], v[54:55], v[26:27], v[48:49] neg_lo:[1,0,0] neg_hi:[1,0,0]
    v_pk_fma_f32 v[64:65], v[58:59], v[30:31], v[64:65] neg_lo:[1,0,0] neg_hi:[1,0,0]
    v_pk_fma_f32 v[50:51], v[54:55], v[24:25], v[50:51]
    v_pk_fma_f32 v[66:67], v[58:59], v[28:29], v[66:67]
    v_cvt_pk_bf16_f32 v132, v48, v50
    v_cvt_pk_bf16_f32 v134, v64, v66
    v_cvt_pk_bf16_f32 v133, v49, v51
    v_cvt_pk_bf16_f32 v135, v65, v67
    ds_write_b64 v9, v[132:133] offset:8704
    ds_write_b64 v9, v[134:135] offset:2176
    s_waitcnt vmcnt(2) lgkmcnt(0)
    s_barrier
    s_cmp_eq_u32 s30, 7
    s_cbranch_scc0 L_k2_g4
    v_add_u32 v104, 149632, v3
    s_mov_b64 exec, 0xff
    ds_read_b64 v[106:107], v104
    s_lshl_b32 s44, s2, 6
    s_waitcnt lgkmcnt(0)
    buffer_store_dwordx2 v[106:107], v3, s[56:59], s44 offen sc1
    s_mov_b64 exec, -1
L_k2_g4:
    v_pk_mul_f32 v[52:53], v[48:49], v[24:25]
    v_pk_mul_f32 v[68:69], v[64:65], v[24:25]
    v_pk_mul_f32 v[54:55], v[48:49], v[26:27]
    v_pk_mul_f32 v[70:71], v[64:65], v[26:27]
    v_pk_fma_f32 v[52:53], v[50:51], v[26:27], v[52:53] neg_lo:[1,0,0] neg_hi:[1,0,0]
    v_pk_fma_f32 v[68:69], v[66:67], v[26:27], v[68:69] neg_lo:[1,0,0] neg_hi:[1,0,0]
    v_pk_fma_f32 v[54:55], v[50:51], v[24:25], v[54:55]
    v_pk_fma_f32 v[70:71], v[66:67], v[24:25], v[70:71]
    v_cvt_pk_bf16_f32 v120, v52, v54
    v_cvt_pk_bf16_f32 v122, v68, v70
    v_cvt_pk_bf16_f32 v121, v53, v55
    v_cvt_pk_bf16_f32 v123, v69, v71
    ds_write_b64 v9, v[120:121] offset:10880
    ds_write_b64 v9, v[122:123] offset:6528
    v_pk_mul_f32 v[48:49], v[52:53], v[24:25]
    v_pk_mul_f32 v[60:61], v[56:57], v[24:25]
    v_pk_mul_f32 v[50:51], v[52:53], v[26:27]
    v_pk_mul_f32 v[62:63], v[56:57], v[26:27]
    v_pk_fma_f32 v[48:49], v[54:55], v[26:27], v[48:49] neg_lo:[1,0,0] neg_hi:[1,0,0]
    v_pk_fma_f32 v[60:61], v[58:59], v[26:27], v[60:61] neg_lo:[1,0,0] neg_hi:[1,0,0]
    v_pk_fma_f32 v[50:51], v[54:55], v[24:25], v[50:51]
    v_pk_fma_f32 v[62:63], v[58:59], v[24:25], v[62:63]
    v_cvt_pk_bf16_f32 v124, v48, v50
    v_cvt_pk_bf16_f32 v126, v60, v62
    v_cvt_pk_bf16_f32 v125, v49, v51
    v_cvt_pk_bf16_f32 v127, v61, v63
    ds_write_b64 v9, v[124:125] offset:13056
    ds_write_b64 v9, v[126:127] offset:5440
    v_pk_mul_f32 v[52:53], v[48:49], v[24:25]
    v_pk_mul_f32 v[64:65], v[68:69], v[24:25]
    v_pk_mul_f32 v[54:55], v[48:49], v[26:27]
    v_pk_mul_f32 v[66:67], v[68:69], v[26:27]
    v_pk_fma_f32 v[52:53], v[50:51], v[26:27], v[52:53] neg_lo:[1,0,0] neg_hi:[1,0,0]
    v_pk_fma_f32 v[64:65], v[70:71], v[26:27], v[64:65] neg_lo:[1,0,0] neg_hi:[1,0,0]
    v_pk_fma_f32 v[54:55], v[50:51], v[24:25], v[54:55]
    v_pk_fma_f32 v[66:67], v[70:71], v[24:25], v[66:67]
    v_cvt_pk_bf16_f32 v128, v52, v54
    v_cvt_pk_bf16_f32 v130, v64, v66
    v_cvt_pk_bf16_f32 v129, v53, v55
    v_cvt_pk_bf16_f32 v131, v65, v67
    ds_write_b64 v9, v[128:129] offset:14144
    ds_write_b64 v9, v[130:131] offset:9792
    buffer_load_dwordx2 v[200:201], v155, s[20:23], s82 offen
    v_pk_mul_f32 v[48:49], v[52:53], v[24:25]
    v_pk_mul_f32 v[56:57], v[60:61], v[24:25]
    v_pk_mul_f32 v[50:51], v[52:53], v[26:27]
    v_pk_mul_f32 v[58:59], v[60:61], v[26:27]
    v_pk_fma_f32 v[48:49], v[54:55], v[26:27], v[48:49] neg_lo:[1,0,0] neg_hi:[1,0,0]
    v_pk_fma_f32 v[56:57], v[62:63], v[26:27], v[56:57] neg_lo:[1,0,0] neg_hi:[1,0,0]
    v_pk_fma_f32 v[50:51], v[54:55], v[24:25], v[50:51]
    v_pk_fma_f32 v[58:59], v[62:63], v[24:25], v[58:59]
    v_cvt_pk_bf16_f32 v132, v48, v50
    v_cvt_pk_bf16_f32 v134, v56, v58
    v_cvt_pk_bf16_f32 v133, v49, v51
    v_cvt_pk_bf16_f32 v135, v57, v59
    ds_write_b64 v9, v[132:133] offset:15232
    ds_write_b64 v9, v[134:135] offset:9248
    v_pk_mul_f32 v[52:53], v[48:49], v[24:25]
    v_pk_mul_f32 v[68:69], v[64:65], v[24:25]
    v_pk_mul_f32 v[54:55], v[48:49], v[26:27]
    v_pk_mul_f32 v[70:71], v[64:65], v[26:27]
    v_pk_fma_f32 v[52:53], v[50:51], v[26:27], v[52:53] neg_lo:[1,0,0] neg_hi:[1,0,0]
    v_pk_fma_f32 v[68:69], v[66:67], v[26:27], v[68:69] neg_lo:[1,0,0] neg_hi:[1,0,0]
    v_pk_fma_f32 v[54:55], v[50:51], v[24:25], v[54:55]
    v_pk_fma_f32 v[70:71], v[66:67], v[24:25], v[70:71]
    v_cvt_pk_bf16_f32 v120, v52, v54
    v_cvt_pk_bf16_f32 v122, v68, v70
    v_cvt_pk_bf16_f32 v121, v53, v55
    v_cvt_pk_bf16_f32 v123, v69, v71
    ds_write_b64 v9, v[120:121] offset:16320
    ds_write_b64 v9, v[122:123] offset:11968
    v_pk_mul_f32 v[48:49], v[52:53], v[24:25]
    v_pk_mul_f32 v[60:61], v[56:57], v[24:25]
    v_pk_mul_f32 v[50:51], v[52:53], v[26:27]
    v_pk_mul_f32 v[62:63], v[56:57], v[26:27]
    v_pk_fma_f32 v[48:49], v[54:55], v[26:27], v[48:49] neg_lo:[1,0,0] neg_hi:[1,0,0]
    v_pk_fma_f32 v[60:61], v[58:59], v[26:27], v[60:61] neg_lo:[1,0,0] neg_hi:[1,0,0]
    v_pk_fma_f32 v[50:51], v[54:55], v[24:25], v[50:51]
    v_pk_fma_f32 v[62:63], v[58:59], v[24:25], v[62:63]
    v_cvt_pk_bf16_f32 v124, v48, v50
    v_cvt_pk_bf16_f32 v126, v60, v62
    v_cvt_pk_bf16_f32 v125, v49, v51
    v_cvt_pk_bf16_f32 v127, v61, v63
    ds_write_b64 v9, v[124:125] offset:17408
    ds_write_b64 v9, v[126:127] offset:11424
    v_pk_mul_f32 v[52:53], v[48:49], v[24:25]
    v_pk_mul_f32 v[64:65], v[68:69], v[24:25]
    v_pk_mul_f32 v[54:55], v[48:49], v[26:27]
    v_pk_mul_f32 v[66:67], v[68:69], v[26:27]
    v_pk_fma_f32 v[52:53], v[50:51], v[26:27], v[52:53] neg_lo:[1,0,0] neg_hi:[1,0,0]
    v_pk_fma_f32 v[64:65], v[70:71], v[26:27], v[64:65] neg_lo:[1,0,0] neg_hi:[1,0,0]
    v_pk_fma_f32 v[54:55], v[50:51], v[24:25], v[54:55]
    v_pk_fma_f32 v[66:67], v[70:71], v[24:25], v[66:67]
    v_cvt_pk_bf16_f32 v128, v52, v54
    v_cvt_pk_bf16_f32 v130, v64, v66
    v_cvt_pk_bf16_f32 v129, v53, v55
    v_cvt_pk_bf16_f32 v131, v65, v67
    ds_write_b64 v9, v[128:129] offset:17952
    ds_write_b64 v9, v[130:131] offset:13600
    buffer_load_dwordx2 v[202:203], v155, s[20:23], s83 offen
    v_pk_mul_f32 v[48:49], v[52:53], v[24:25]
    v_pk_mul_f32 v[68:69], v[64:65], v[24:25]
    v_pk_mul_f32 v[50:51], v[52:53], v[26:27]
    v_pk_mul_f32 v[70:71], v[64:65], v[26:27]
    v_pk_fma_f32 v[48:49], v[54:55], v[26:27], v[48:49] neg_lo:[1,0,0] neg_hi:[1,0,0]
    v_pk_fma_f32 v[68:69], v[66:67], v[26:27], v[68:69] neg_lo:[1,0,0] neg_hi:[1,0,0]
    v_pk_fma_f32 v[50:51], v[54:55], v[24:25], v[50:51]
    v_pk_fma_f32 v[70:71], v[66:67], v[24:25], v[70:71]
    v_cvt_pk_bf16_f32 v132, v48, v50
    v_cvt_pk_bf16_f32 v134, v68, v70
    v_cvt_pk_bf16_f32 v133, v49, v51
    v_cvt_pk_bf16_f32 v135, v69, v71
    ds_write_b64 v9, v[132:133] offset:18496
    ds_write_b64 v9, v[134:135] offset:14688
    v_pk_mul_f32 v[52:53], v[48:49], v[24:25]
    v_pk_mul_f32 v[64:65], v[68:69], v[24:25]
    v_pk_mul_f32 v[54:55], v[48:49], v[26:27]
    v_pk_mul_f32 v[66:67], v[68:69], v[26:27]
    v_pk_fma_f32 v[52:53], v[50:51], v[26:27], v[52:53] neg_lo:[1,0,0] neg_hi:[1,0,0]
    v_pk_fma_f32 v[64:65], v[70:71], v[26:27], v[64:65] neg_lo:[1,0,0] neg_hi:[1,0,0]
    v_pk_fma_f32 v[54:55], v[50:51], v[24:25], v[54:55]
    v_pk_fma_f32 v[66:67], v[70:71], v[24:25], v[66:67]
    v_cvt_pk_bf16_f32 v120, v52, v54
    v_cvt_pk_bf16_f32 v122, v64, v66
    v_cvt_pk_bf16_f32 v121, v53, v55
    v_cvt_pk_bf16_f32 v123, v65, v67
    ds_write_b64 v9, v[120:121] offset:19040
    ds_write_b64 v9, v[122:123] offset:15776
    v_pk_mul_f32 v[48:49], v[52:53], v[24:25]
    v_pk_mul_f32 v[68:69], v[64:65], v[24:25]
    v_pk_mul_f32 v[50:51], v[52:53], v[26:27]
    v_pk_mul_f32 v[70:71], v[64:65], v[26:27]
    v_pk_fma_f32 v[48:49], v[54:55], v[26:27], v[48:49] neg_lo:[1,0,0] neg_hi:[1,0,0]
    v_pk_fma_f32 v[68:69], v[66:67], v[26:27], v[68:69] neg_lo:[1,0,0] neg_hi:[1,0,0]
    v_pk_fma_f32 v[50:51], v[54:55], v[24:25], v[50:51]
    v_pk_fma_f32 v[70:71], v[66:67], v[24:25], v[70:71]
    v_cvt_pk_bf16_f32 v124, v48, v50
    v_cvt_pk_bf16_f32 v126, v68, v70
    v_cvt_pk_bf16_f32 v125, v49, v51
    v_cvt_pk_bf16_f32 v127, v69, v71
    ds_write_b64 v9, v[124:125] offset:19584
    ds_write_b64 v9, v[126:127] offset:16864
    v_pk_mul_f32 v[52:53], v[48:49], v[24:25]
    v_pk_mul_f32 v[54:55], v[48:49], v[26:27]
    v_pk_fma_f32 v[52:53], v[50:51], v[26:27], v[52:53] neg_lo:[1,0,0] neg_hi:[1,0,0]
    v_pk_fma_f32 v[54:55], v[50:51], v[24:25], v[54:55]
    v_cvt_pk_bf16_f32 v128, v52, v54
    v_cvt_pk_bf16_f32 v129, v53, v55
    ds_write_b64 v9, v[128:129] offset:20128
    v_pk_mul_f32 v[48:49], v[52:53], v[24:25]
    v_pk_mul_f32 v[50:51], v[52:53], v[26:27]
    v_pk_fma_f32 v[48:49], v[54:55], v[26:27], v[48:49] neg_lo:[1,0,0] neg_hi:[1,0,0]
    v_pk_fma_f32 v[50:51], v[54:55], v[24:25], v[50:51]
    v_cvt_pk_bf16_f32 v130, v48, v50
    v_cvt_pk_bf16_f32 v131, v49, v51
    ds_write_b64 v9, v[130:131] offset:20672
    v_pk_mul_f32 v[52:53], v[48:49], v[24:25]
    v_pk_mul_f32 v[54:55], v[48:49], v[26:27]
    v_pk_fma_f32 v[52:53], v[50:51], v[26:27], v[52:53] neg_lo:[1,0,0] neg_hi:[1,0,0]
    v_pk_fma_f32 v[54:55], v[50:51], v[24:25], v[54:55]
    v_cvt_pk_bf16_f32 v132, v52, v54
    v_cvt_pk_bf16_f32 v133, v53, v55
    ds_write_b64 v9, v[132:133] offset:21216
    v_pk_mul_f32 v[48:49], v[52:53], v[24:25]
    v_pk_mul_f32 v[50:51], v[52:53], v[26:27]
    v_pk_fma_f32 v[48:49], v[54:55], v[26:27], v[48:49] neg_lo:[1,0,0] neg_hi:[1,0,0]
    v_pk_fma_f32 v[50:51], v[54:55], v[24:25], v[50:51]
    v_cvt_pk_bf16_f32 v134, v48, v50
    v_cvt_pk_bf16_f32 v135, v49, v51
    ds_write_b64 v9, v[134:135] offset:21760
L_k2_kg2:
    v_add_f32 v8, v8, v8
    s_mul_i32 s35, s27, 1536
    s_add_u32 s35, s35, 142464
    s_waitcnt lgkmcnt(0)
    s_barrier
    ds_read_b128 v[16:19], v12 offset:22304
    ds_read_b128 v[20:23], v12 offset:22368
    ds_read_b128 v[24:27], v12 offset:22432
    ds_read_b128 v[28:31], v12 offset:22496
    ds_read_b128 v[32:35], v12 offset:22560
    ds_read_b128 v[36:39], v12 offset:22624
    ds_read_b128 v[40:43], v12 offset:22688
    ds_read_b128 v[44:47], v12 offset:22752
    s_cmp_ge_u32 s30, 4
    s_cbranch_scc1 L_k2_mB
    ds_read_b128 v[48:51], v12 offset:0
    ds_read_b128 v[52:55], v12 offset:64
    ds_read_b128 v[56:59], v12 offset:128
    ds_read_b128 v[60:63], v12 offset:192
    ds_read_b128 v[64:67], v12 offset:256
    ds_read_b128 v[68:71], v12 offset:320
    ds_read_b128 v[72:75], v12 offset:384
    ds_read_b128 v[76:79], v12 offset:448
    ds_read_b128 v[80:83], v12 offset:8704
    ds_read_b128 v[84:87], v12 offset:8768
    ds_read_b128 v[88:91], v12 offset:8832
    ds_read_b128 v[92:95], v12 offset:8896
    ds_read_b128 v[96:99], v12 offset:8960
    ds_read_b128 v[100:103], v12 offset:9024
    ds_read_b128 v[104:107], v12 offset:9088
    ds_read_b128 v[108:111], v12 offset:9152
    v_lshrrev_b32 v2, 1, v11
    v_and_b32 v13, 1, v11
    v_lshlrev_b32 v4, 8, v2
    v_lshl_add_u32 v4, v13, 3, v4
    v_lshl_add_u32 v4, v10, 4, v4
    v_add_u32 v4, s35, v4
    v_lshlrev_b32 v5, 7, v11
    v_lshlrev_b32 v6, 3, v10
    v_lshlrev_b32 v7, 2, v10
    v_cmp_gt_u32 vcc, 2, v11
    v_mov_b32 v13, 64
    v_mov_b32 v15, 4
    v_cndmask_b32 v6, v7, v6, vcc
    v_cndmask_b32 v7, v13, v15, vcc
    v_add3_u32 v5, v5, v6, s35
    v_add_u32 v6, v5, v7
    v_mov_b32 v156, 0
    v_writelane_b32 v156, s26, 0
    s_waitcnt lgkmcnt(8)
    v_mfma_f32_16x16x32_bf16 v[112:115], v[48:51], v[16:19], 0
    v_mfma_f32_16x16x32_bf16 v[112:115], v[52:55], v[20:23], v[112:115]
    v_mfma_f32_16x16x32_bf16 v[112:115], v[56:59], v[24:27], v[112:115]
    v_mfma_f32_16x16x32_bf16 v[112:115], v[60:63], v[28:31], v[112:115]
    v_mfma_f32_16x16x32_bf16 v[112:115], v[64:67], v[32:35], v[112:115]
    v_mfma_f32_16x16x32_bf16 v[112:115], v[68:71], v[36:39], v[112:115]
    v_mfma_f32_16x16x32_bf16 v[112:115], v[72:75], v[40:43], v[112:115]
    v_mfma_f32_16x16x32_bf16 v[112:115], v[76:79], v[44:47], v[112:115]
    s_waitcnt lgkmcnt(0)
    v_mfma_f32_16x16x32_bf16 v[116:119], v[80:83], v[16:19], 0
    v_mfma_f32_16x16x32_bf16 v[116:119], v[84:87], v[20:23], v[116:119]
    v_mfma_f32_16x16x32_bf16 v[116:119], v[88:91], v[24:27], v[116:119]
    v_mfma_f32_16x16x32_bf16 v[116:119], v[92:95], v[28:31], v[116:119]
    v_mfma_f32_16x16x32_bf16 v[116:119], v[96:99], v[32:35], v[116:119]
    v_mfma_f32_16x16x32_bf16 v[116:119], v[100:103], v[36:39], v[116:119]
    v_mfma_f32_16x16x32_bf16 v[116:119], v[104:107], v[40:43], v[116:119]
    v_mfma_f32_16x16x32_bf16 v[116:119], v[108:111], v[44:47], v[116:119]
    v_fma_f32 v112, v112, v8, v156
    v_mul_f32 v113, v113, v8
    v_mul_f32 v114, v114, v8
    v_mul_f32 v115, v115, v8
    v_cvt_pk_bf16_f32 v16, v112, v113
    v_cvt_pk_bf16_f32 v17, v114, v115
    ds_write_b64 v4, v[16:17]
    s_nop 1
    v_mul_f32 v116, v116, v8
    v_mul_f32 v117, v117, v8
    v_mul_f32 v118, v118, v8
    v_mul_f32 v119, v119, v8
    v_cvt_pk_bf16_f32 v18, v116, v117
    v_cvt_pk_bf16_f32 v19, v118, v119
    ds_write_b32 v5, v18 offset:512
    ds_write_b32 v6, v19 offset:512
    s_branch L_k2_kg3
L_k2_mB:
    ds_read_b128 v[48:51], v12 offset:17408
    ds_read_b128 v[52:55], v12 offset:17472
    ds_read_b128 v[56:59], v12 offset:17536
    ds_read_b128 v[60:63], v12 offset:17600
    ds_read_b128 v[64:67], v12 offset:17664
    ds_read_b128 v[68:71], v12 offset:17728
    ds_read_b128 v[72:75], v12 offset:17792
    ds_read_b128 v[76:79], v12 offset:17856
    v_lshlrev_b32 v7, 7, v11
    v_lshl_add_u32 v7, v10, 1, v7
    v_add_u32 v7, s35, v7
    s_waitcnt lgkmcnt(0)
    v_mfma_f32_16x16x32_bf16 v[112:115], v[48:51], v[16:19], 0
    v_mfma_f32_16x16x32_bf16 v[112:115], v[52:55], v[20:23], v[112:115]
    v_mfma_f32_16x16x32_bf16 v[112:115], v[56:59], v[24:27], v[112:115]
    v_mfma_f32_16x16x32_bf16 v[112:115], v[60:63], v[28:31], v[112:115]
    v_mfma_f32_16x16x32_bf16 v[112:115], v[64:67], v[32:35], v[112:115]
    v_mfma_f32_16x16x32_bf16 v[112:115], v[68:71], v[36:39], v[112:115]
    v_mfma_f32_16x16x32_bf16 v[112:115], v[72:75], v[40:43], v[112:115]
    v_mfma_f32_16x16x32_bf16 v[112:115], v[76:79], v[44:47], v[112:115]
    s_nop 7
    v_mul_f32 v112, v112, v8
    v_mul_f32 v113, v113, v8
    v_mul_f32 v114, v114, v8
    v_mul_f32 v115, v115, v8
    v_cvt_pk_bf16_f32 v20, v112, v113
    v_cvt_pk_bf16_f32 v21, v114, v115
    ds_write_b16 v7, v20 offset:1024
    ds_write_b16_d16_hi v7, v20 offset:1056
    ds_write_b16 v7, v21 offset:1088
    ds_write_b16_d16_hi v7, v21 offset:1120
L_k2_kg3:
    buffer_load_dwordx4 v[160:163], v154, s[76:79], 0 offen offset:0 sc1
    buffer_load_dwordx4 v[164:167], v154, s[76:79], 0 offen offset:1024 sc1
    buffer_load_dwordx2 v[168:169], v205, s[76:79], 0 offen sc1
    s_mov_b32 s36, 0x01000302
    s_mov_b32 s37, 0x01000100
    s_mov_b32 s38, 0x03020302
    s_mov_b32 s39, 0x03020504
    s_mov_b32 s40, 0x01000504
    s_mul_i32 s33, s27, 4608
    s_add_u32 s33, s33, 124032
    s_waitcnt lgkmcnt(0)
    s_barrier
    s_cmp_ge_u32 s30, 4
    s_cbranch_scc1 L_k2_xB
    v_add_u32 v4, s35, v3
    v_lshl_add_u32 v5, v14, 2, s35
    ds_read_b64 v[16:17], v4
    ds_read2_b32 v[18:19], v5 offset0:128 offset1:129
    ds_read2_b32 v[20:21], v5 offset0:192 offset1:193
    s_branch L_k2_x2
L_k2_xB:
    v_lshl_add_u32 v4, v14, 1, s35
    ds_read_u16 v22, v4 offset:1024
    ds_read_u16 v23, v4 offset:1026
    ds_read_u16 v24, v4 offset:1152
    ds_read_u16 v25, v4 offset:1154
L_k2_x2:
    v_sub_u32 v6, 504, v3
    v_add_u32 v6, s33, v6
    v_lshlrev_b32 v7, 4, v14
    v_sub_u32 v7, 1008, v7
    v_add_u32 v7, s33, v7
    v_mov_b32 v44, 0
    v_mov_b32 v45, 0
    s_waitcnt lgkmcnt(0)
    s_cmp_ge_u32 s30, 4
    s_cbranch_scc1 L_k2_yB
    v_perm_b32 v28, v17, v17, s36
    v_perm_b32 v29, v16, v16, s36
    v_perm_b32 v30, v19, v18, s39
    v_perm_b32 v31, v18, v18, s37
    v_perm_b32 v32, v21, v21, s37
    v_perm_b32 v33, v20, v20, s38
    v_perm_b32 v34, v20, v20, s36
    v_perm_b32 v35, v20, v20, s37
    ds_write_b64 v6, v[28:29] offset:3584
    ds_write_b64 v6, v[30:31] offset:3072
    ds_write_b128 v7, v[32:35] offset:2048
    v_bfe_u32 v4, v14, 2, 2
    v_mul_u32_u24 v4, 4160, v4
    v_and_b32 v5, 3, v14
    v_lshl_add_u32 v4, v5, 3, v4
    s_mul_i32 s34, s27, 16672
    v_add_u32 v4, s34, v4
    ds_write_b64 v4, v[44:45]
    s_branch L_k2_y2
L_k2_yB:
    v_and_b32 v5, 1, v14
    v_cmp_eq_u32 vcc, 1, v5
    v_perm_b32 v36, v23, v23, s37
    v_perm_b32 v38, v22, v22, s37
    v_cndmask_b32 v26, v22, v23, vcc
    v_cndmask_b32 v27, v24, v25, vcc
    v_perm_b32 v37, v23, v26, s40
    v_mov_b32 v39, v38
    v_perm_b32 v40, v25, v25, s37
    v_perm_b32 v41, v25, v27, s40
    v_perm_b32 v42, v24, v24, s37
    v_mov_b32 v43, v42
    ds_write_b128 v7, v[36:39] offset:1024
    ds_write_b128 v7, v[40:43]
    ds_write_b64 v6, v[44:45] offset:4096
L_k2_y2:
    v_mul_u32_u24 v2, 16672, v153
    v_and_b32 v4, 60, v14
    v_lshl_add_u32 v2, v4, 2, v2
    s_lshl_b32 s41, s30, 9
    v_add_u32 v2, s41, v2
    v_add_u32 v156, 60, v14
    v_and_b32 v156, 63, v156
    v_lshlrev_b32 v156, 2, v156
    s_mov_b32 s64, 0
    s_mov_b64 s[44:45], 15
    s_mov_b32 s41, 0
    s_cmp_eq_u32 s30, 0
    s_cselect_b32 s42, 0, s13
    s_waitcnt vmcnt(0)
L_k2_poll:
    v_xor_b32 v172, s13, v161
    v_xor_b32 v173, s13, v163
    v_xor_b32 v174, s13, v165
    v_xor_b32 v175, s13, v167
    v_xor_b32 v176, s42, v169
    v_or3_b32 v172, v172, v173, v174
    v_or3_b32 v172, v172, v175, v176
    v_cmp_ne_u32 vcc, 0, v172
    s_add_u32 s41, s41, 1
    s_cbranch_vccz L_k2_seen
    s_cmp_ge_u32 s41, 0x80000
    s_cbranch_scc1 L_k2_seen
    s_sleep 4
    buffer_load_dwordx4 v[160:163], v154, s[76:79], 0 offen offset:0 sc1
    buffer_load_dwordx4 v[164:167], v154, s[76:79], 0 offen offset:1024 sc1
    buffer_load_dwordx2 v[168:169], v205, s[76:79], 0 offen sc1
    s_waitcnt vmcnt(0)
    s_branch L_k2_poll
L_k2_seen:
    s_cmp_ge_u32 s30, 4
    s_cbranch_scc0 L_k2_nec
    s_cmp_ge_u32 s2, 224
    s_cbranch_scc1 L_k2_nec
    s_mov_b32 s64, 1
    s_lshr_b32 s33, s2, 3
    s_cmp_ge_u32 s33, 14
    s_cselect_b32 s32, 1, 0
    s_cselect_b32 s34, 14, 0
    s_sub_u32 s33, s33, s34
    s_cmp_ge_u32 s33, 7
    s_cselect_b32 s84, s10, s8
    s_cselect_b32 s85, s11, s9
    s_cselect_b32 s34, 7, 0
    s_cselect_b32 s43, 56, 0
    s_mov_b32 s86, 0x00700000
    s_mov_b32 s87, 0x00020000
    s_sub_u32 s34, s33, s34
    s_and_b32 s35, s2, 7
    s_mul_i32 s35, s35, 7
    s_add_u32 s34, s34, s35
    s_add_u32 s33, s34, s43
    s_lshl_b32 s34, s34, 7
    s_lshl_b32 s35, s32, 2
    s_add_u32 s35, s35, s27
    s_mul_i32 s35, s35, 917504
    s_add_u32 s35, s35, s34
    v_lshrrev_b32 v15, 3, v14
    v_mul_u32_u24 v15, 7168, v15
    v_and_b32 v13, 7, v14
    v_lshl_add_u32 v15, v13, 4, v15
    buffer_load_dwordx4 v[212:215], v15, s[84:87], s35 offen
    s_add_u32 s35, s35, 57344
    buffer_load_dwordx4 v[216:219], v15, s[84:87], s35 offen
    s_add_u32 s35, s35, 57344
    buffer_load_dwordx4 v[220:223], v15, s[84:87], s35 offen
    s_add_u32 s35, s35, 57344
    buffer_load_dwordx4 v[224:227], v15, s[84:87], s35 offen
    s_add_u32 s35, s35, 57344
    buffer_load_dwordx4 v[228:231], v15, s[84:87], s35 offen
    s_add_u32 s35, s35, 57344
L_k2_nec:
    s_mov_b32 vcc_lo, 0xaaaaaaaa
    s_mov_b32 vcc_hi, 0xaaaaaaaa
    v_mov_b32_dpp v172, v162 quad_perm:[0,0,1,1] row_mask:0xf bank_mask:0xf
    v_mov_b32_dpp v173, v162 quad_perm:[2,2,3,3] row_mask:0xf bank_mask:0xf
    v_mov_b32_dpp v174, v166 quad_perm:[0,0,1,1] row_mask:0xf bank_mask:0xf
    v_mov_b32_dpp v175, v166 quad_perm:[2,2,3,3] row_mask:0xf bank_mask:0xf
    v_cndmask_b32_dpp v162, v160, v173, vcc quad_perm:[2,2,3,3] row_mask:0xf bank_mask:0xf
    v_cndmask_b32_dpp v160, v160, v172, vcc quad_perm:[0,0,1,1] row_mask:0xf bank_mask:0xf
    v_cndmask_b32_dpp v166, v164, v175, vcc quad_perm:[2,2,3,3] row_mask:0xf bank_mask:0xf
    v_cndmask_b32_dpp v164, v164, v174, vcc quad_perm:[0,0,1,1] row_mask:0xf bank_mask:0xf
    v_and_b32 v161, s47, v160
    v_and_b32 v163, s47, v162
    v_and_b32 v165, s47, v164
    v_and_b32 v167, s47, v166
    v_and_b32 v169, s47, v168
    v_max_f32 v169, 0x00800000, v169
    v_rcp_f32 v172, v161
    v_rcp_f32 v173, v163
    v_rcp_f32 v174, v165
    v_rcp_f32 v175, v167
    v_rcp_f32 v176, v169
    v_lshlrev_b32 v161, 16, v160
    v_lshlrev_b32 v163, 16, v162
    v_lshlrev_b32 v165, 16, v164
    v_lshlrev_b32 v167, 16, v166
    v_lshlrev_b32 v169, 16, v168
    v_mov_b32 v160, v172
    v_mul_f32 v161, v161, v172
    v_mov_b32 v162, v173
    v_mul_f32 v163, v163, v173
    v_mov_b32 v164, v174
    v_mul_f32 v165, v165, v174
    v_mov_b32 v166, v175
    v_mul_f32 v167, v167, v175
    v_mov_b32 v168, v176
    v_mul_f32 v169, v169, v176
    v_and_b32 v157, 1, v14
    v_cmp_eq_u32 vcc, 1, v157
    v_mov_b32 v157, 0x05040100
    v_mov_b32 v158, 0x03020706
    v_cndmask_b32 v159, v157, v158, vcc
    v_lshlrev_b32 v236, 16, v198
    v_and_b32 v237, s47, v198
    v_lshlrev_b32 v238, 16, v199
    v_and_b32 v239, s47, v199
    v_pk_fma_f32 v[172:173], v[236:237], v[162:163], v[162:163] op_sel:[0,0,1] op_sel_hi:[1,0,1] neg_lo:[0,0,1] neg_hi:[0,0,1]
    v_pk_fma_f32 v[174:175], v[238:239], v[162:163], v[162:163] op_sel:[0,0,1] op_sel_hi:[1,0,1] neg_lo:[0,0,1] neg_hi:[0,0,1]
    v_cvt_pk_bf16_f32 v184, v172, v173
    v_cvt_pk_bf16_f32 v185, v174, v175
    v_lshlrev_b32 v232, 16, v196
    v_and_b32 v233, s47, v196
    v_lshlrev_b32 v234, 16, v197
    v_and_b32 v235, s47, v197
    v_pk_fma_f32 v[176:177], v[232:233], v[160:161], v[160:161] op_sel:[0,0,1] op_sel_hi:[1,0,1] neg_lo:[0,0,1] neg_hi:[0,0,1]
    v_pk_fma_f32 v[178:179], v[234:235], v[160:161], v[160:161] op_sel:[0,0,1] op_sel_hi:[1,0,1] neg_lo:[0,0,1] neg_hi:[0,0,1]
    v_cvt_pk_bf16_f32 v186, v176, v177
    v_cvt_pk_bf16_f32 v187, v178, v179
    v_lshlrev_b32 v180, 16, v170
    v_and_b32 v181, s47, v170
    v_lshlrev_b32 v182, 16, v171
    v_and_b32 v183, s47, v171
    v_pk_fma_f32 v[180:181], v[180:181], v[168:169], v[168:169] op_sel:[0,0,1] op_sel_hi:[1,0,1] neg_lo:[0,0,1] neg_hi:[0,0,1]
    v_pk_fma_f32 v[182:183], v[182:183], v[168:169], v[168:169] op_sel:[0,0,1] op_sel_hi:[1,0,1] neg_lo:[0,0,1] neg_hi:[0,0,1]
    v_cvt_pk_bf16_f32 v188, v180, v181
    v_cvt_pk_bf16_f32 v189, v182, v183
    s_mov_b32 vcc_lo, 0x33333333
    s_mov_b32 vcc_hi, 0x33333333
    v_cndmask_b32_dpp v172, v185, v184, vcc quad_perm:[2,3,0,1] row_mask:0xf bank_mask:0xf
    v_cndmask_b32_dpp v174, v187, v186, vcc quad_perm:[2,3,0,1] row_mask:0xf bank_mask:0xf
    v_cndmask_b32_dpp v176, v189, v188, vcc quad_perm:[2,3,0,1] row_mask:0xf bank_mask:0xf
    s_not_b64 vcc, vcc
    v_cndmask_b32_dpp v173, v184, v185, vcc quad_perm:[2,3,0,1] row_mask:0xf bank_mask:0xf
    v_cndmask_b32_dpp v175, v186, v187, vcc quad_perm:[2,3,0,1] row_mask:0xf bank_mask:0xf
    v_cndmask_b32_dpp v177, v188, v189, vcc quad_perm:[2,3,0,1] row_mask:0xf bank_mask:0xf
    v_mov_b32_dpp v178, v172 quad_perm:[1,0,3,2] row_mask:0xf bank_mask:0xf
    v_mov_b32_dpp v180, v174 quad_perm:[1,0,3,2] row_mask:0xf bank_mask:0xf
    v_mov_b32_dpp v182, v176 quad_perm:[1,0,3,2] row_mask:0xf bank_mask:0xf
    v_mov_b32_dpp v179, v173 quad_perm:[1,0,3,2] row_mask:0xf bank_mask:0xf
    v_mov_b32_dpp v181, v175 quad_perm:[1,0,3,2] row_mask:0xf bank_mask:0xf
    v_mov_b32_dpp v183, v177 quad_perm:[1,0,3,2] row_mask:0xf bank_mask:0xf
    v_perm_b32 v142, v178, v172, v159
    v_perm_b32 v143, v179, v173, v159
    v_perm_b32 v140, v180, v174, v159
    v_perm_b32 v141, v181, v175, v159
    v_perm_b32 v190, v182, v176, v159
    v_perm_b32 v191, v183, v177, v159
    ds_bpermute_b32 v192, v156, v142
    ds_bpermute_b32 v193, v156, v143
    ds_write_b128 v2, v[140:143] offset:12512
    v_alignbit_b32 v98, v141, v140, 16
    v_alignbit_b32 v99, v142, v141, 16
    v_mov_b32 v101, v140
    v_mov_b32 v102, v141
    v_mov_b32 v103, v142
    v_mov_b32 v105, v98
    v_mov_b32 v106, v99
    v_alignbit_b32 v107, v143, v142, 16
    s_waitcnt lgkmcnt(1)
    v_cndmask_b32 v148, v192, v190, s[44:45]
    v_cndmask_b32 v149, v193, v191, s[44:45]
    v_mov_b32 v100, v149
    ds_write_b128 v2, v[100:103] offset:4192
    v_alignbit_b32 v104, v140, v149, 16
    ds_write_b128 v2, v[104:107] offset:8352
    v_alignbit_b32 v96, v149, v148, 16
    v_mov_b32 v97, v104
    ds_write_b128 v2, v[96:99] offset:32
    v_lshlrev_b32 v244, 16, v202
    v_and_b32 v245, s47, v202
    v_lshlrev_b32 v246, 16, v203
    v_and_b32 v247, s47, v203
    v_pk_fma_f32 v[172:173], v[244:245], v[166:167], v[166:167] op_sel:[0,0,1] op_sel_hi:[1,0,1] neg_lo:[0,0,1] neg_hi:[0,0,1]
    v_pk_fma_f32 v[174:175], v[246:247], v[166:167], v[166:167] op_sel:[0,0,1] op_sel_hi:[1,0,1] neg_lo:[0,0,1] neg_hi:[0,0,1]
    v_cvt_pk_bf16_f32 v184, v172, v173
    v_cvt_pk_bf16_f32 v185, v174, v175
    v_lshlrev_b32 v240, 16, v200
    v_and_b32 v241, s47, v200
    v_lshlrev_b32 v242, 16, v201
    v_and_b32 v243, s47, v201
    v_pk_fma_f32 v[176:177], v[240:241], v[164:165], v[164:165] op_sel:[0,0,1] op_sel_hi:[1,0,1] neg_lo:[0,0,1] neg_hi:[0,0,1]
    v_pk_fma_f32 v[178:179], v[242:243], v[164:165], v[164:165] op_sel:[0,0,1] op_sel_hi:[1,0,1] neg_lo:[0,0,1] neg_hi:[0,0,1]
    v_cvt_pk_bf16_f32 v186, v176, v177
    v_cvt_pk_bf16_f32 v187, v178, v179
    s_mov_b32 vcc_lo, 0x33333333
    s_mov_b32 vcc_hi, 0x33333333
    v_cndmask_b32_dpp v172, v185, v184, vcc quad_perm:[2,3,0,1] row_mask:0xf bank_mask:0xf
    v_cndmask_b32_dpp v174, v187, v186, vcc quad_perm:[2,3,0,1] row_mask:0xf bank_mask:0xf
    s_not_b64 vcc, vcc
    v_cndmask_b32_dpp v173, v184, v185, vcc quad_perm:[2,3,0,1] row_mask:0xf bank_mask:0xf
    v_cndmask_b32_dpp v175, v186, v187, vcc quad_perm:[2,3,0,1] row_mask:0xf bank_mask:0xf
    v_mov_b32_dpp v178, v172 quad_perm:[1,0,3,2] row_mask:0xf bank_mask:0xf
    v_mov_b32_dpp v180, v174 quad_perm:[1,0,3,2] row_mask:0xf bank_mask:0xf
    v_mov_b32_dpp v179, v173 quad_perm:[1,0,3,2] row_mask:0xf bank_mask:0xf
    v_mov_b32_dpp v181, v175 quad_perm:[1,0,3,2] row_mask:0xf bank_mask:0xf
    v_perm_b32 v146, v178, v172, v159
    v_perm_b32 v147, v179, v173, v159
    v_perm_b32 v144, v180, v174, v159
    v_perm_b32 v145, v181, v175, v159
    ds_bpermute_b32 v194, v156, v146
    ds_bpermute_b32 v195, v156, v147
    ds_write_b128 v2, v[144:147] offset:12768
    v_alignbit_b32 v110, v145, v144, 16
    v_alignbit_b32 v111, v146, v145, 16
    v_mov_b32 v113, v144
    v_mov_b32 v114, v145
    v_mov_b32 v115, v146
    v_mov_b32 v117, v110
    v_mov_b32 v118, v111
    v_alignbit_b32 v119, v147, v146, 16
    s_waitcnt lgkmcnt(1)
    v_cndmask_b32 v148, v194, v192, s[44:45]
    v_cndmask_b32 v149, v195, v193, s[44:45]
    v_mov_b32 v112, v149
    ds_write_b128 v2, v[112:115] offset:4448
    v_alignbit_b32 v116, v144, v149, 16
    ds_write_b128 v2, v[116:119] offset:8608
    v_alignbit_b32 v108, v149, v148, 16
    v_mov_b32 v109, v116
    ds_write_b128 v2, v[108:111] offset:288
    s_cmp_ge_u32 s30, 4
    s_cbranch_scc1 L_k2_noad
    v_lshrrev_b32 v248, 2, v10
    v_mul_u32_u24 v248, 16672, v248
    v_lshl_add_u32 v248, v153, 4, v248
    v_lshl_add_u32 v248, v11, 6, v248
    s_lshl_b32 s36, s30, 9
    v_add_u32 v248, s36, v248
    s_lshl_b32 s37, s3, 14
    s_lshl_b32 s36, s30, 11
    s_add_u32 s36, s36, s37
    v_lshl_add_u32 v249, v14, 4, s36
    s_mov_b32 vcc_lo, 0x33333333
    s_mov_b32 vcc_hi, 0x33333333
    s_add_u32 s40, s16, 0x00c00000
    s_addc_u32 s41, s17, 0
    s_mov_b32 s42, 0x00400000
    s_mov_b32 s43, 0x00020000
    v_and_b32 v13, 3, v10
    v_mul_u32_u24 v13, 4160, v13
    v_lshrrev_b32 v15, 2, v10
    v_lshl_add_u32 v15, v11, 1, v15
    v_lshl_add_u32 v13, v15, 3, v13
    v_add_u32 v13, s34, v13
    s_add_u32 s33, s33, 480
    v_lshlrev_b32 v15, 5, v10
    v_sub_u32 v15, s33, v15
    v_lshl_add_u32 v15, v11, 4, v15
    v_lshlrev_b32 v157, 5, v10
    v_lshl_add_u32 v157, v11, 3, v157
    v_add_u32 v158, s34, v157
L_k2_noad:
    s_waitcnt lgkmcnt(0)
    s_barrier
    s_cmp_ge_u32 s30, 4
    s_cbranch_scc1 L_k2_bg
    s_setprio 2
    ds_read_b64 v[16:17], v13 offset:8
    ds_read_b64 v[18:19], v13 offset:16
    ds_read_b128 v[48:51], v15 offset:3584
    ds_read_b64 v[20:21], v13 offset:520
    ds_read_b64 v[22:23], v13 offset:528
    ds_read_b128 v[52:55], v15 offset:3072
    ds_read_b64 v[24:25], v13 offset:1032
    ds_read_b64 v[26:27], v13 offset:1040
    ds_read_b128 v[56:59], v15 offset:2560
    ds_read_b64 v[28:29], v13 offset:1544
    ds_read_b64 v[30:31], v13 offset:1552
    ds_read_b128 v[60:63], v15 offset:2048
    s_waitcnt lgkmcnt(9)
    v_mfma_f32_16x16x32_bf16 v[160:163], v[16:19], v[48:51], 0
    ds_read_b64 v[32:33], v13 offset:2056
    ds_read_b64 v[34:35], v13 offset:2064
    s_waitcnt lgkmcnt(8)
    v_mfma_f32_16x16x32_bf16 v[164:167], v[16:19], v[52:55], 0
    ds_read_b128 v[64:67], v15 offset:1536
    v_mfma_f32_16x16x32_bf16 v[164:167], v[20:23], v[48:51], v[164:167]
    ds_read_b64 v[36:37], v13 offset:2568
    v_mfma_f32_16x16x32_bf16 v[168:171], v[20:23], v[52:55], 0
    ds_read_b64 v[38:39], v13 offset:2576
    s_waitcnt lgkmcnt(8)
    v_mfma_f32_16x16x32_bf16 v[168:171], v[16:19], v[56:59], v[168:171]
    ds_read_b128 v[68:71], v15 offset:1024
    v_mfma_f32_16x16x32_bf16 v[168:171], v[24:27], v[48:51], v[168:171]
    ds_read_b64 v[40:41], v13 offset:3080
    ds_read_b64 v[42:43], v13 offset:3088
    v_mfma_f32_16x16x32_bf16 v[172:175], v[20:23], v[56:59], 0
    ds_read_b128 v[72:75], v15 offset:512
    v_mfma_f32_16x16x32_bf16 v[172:175], v[24:27], v[52:55], v[172:175]
    ds_read_b64 v[44:45], v13 offset:3592
    v_mfma_f32_16x16x32_bf16 v[176:179], v[24:27], v[56:59], 0
    ds_read_b64 v[46:47], v13 offset:3600
    s_waitcnt lgkmcnt(11)
    v_mfma_f32_16x16x32_bf16 v[172:175], v[16:19], v[60:63], v[172:175]
    ds_read_b128 v[76:79], v15 offset:0
    v_mfma_f32_16x16x32_bf16 v[172:175], v[28:31], v[48:51], v[172:175]
    ds_read_b64 v[80:81], v13 offset:72
    ds_read_b64 v[82:83], v13 offset:80
    v_mfma_f32_16x16x32_bf16 v[176:179], v[20:23], v[60:63], v[176:179]
    ds_read_b128 v[112:115], v15 offset:3648
    v_mfma_f32_16x16x32_bf16 v[176:179], v[28:31], v[52:55], v[176:179]
    ds_read_b64 v[84:85], v13 offset:584
    v_mfma_f32_16x16x32_bf16 v[180:183], v[24:27], v[60:63], 0
    ds_read_b64 v[86:87], v13 offset:592
    v_mfma_f32_16x16x32_bf16 v[180:183], v[28:31], v[56:59], v[180:183]
    ds_read_b128 v[116:119], v15 offset:3136
    v_mfma_f32_16x16x32_bf16 v[184:187], v[28:31], v[60:63], 0
    ds_read_b64 v[88:89], v13 offset:1096
    ds_read_b64 v[90:91], v13 offset:1104
    s_waitcnt lgkmcnt(14)
    v_mfma_f32_16x16x32_bf16 v[176:179], v[16:19], v[64:67], v[176:179]
    ds_read_b128 v[120:123], v15 offset:2624
    v_mfma_f32_16x16x32_bf16 v[176:179], v[32:35], v[48:51], v[176:179]
    ds_read_b64 v[92:93], v13 offset:1608
    v_mfma_f32_16x16x32_bf16 v[180:183], v[20:23], v[64:67], v[180:183]
    ds_read_b64 v[94:95], v13 offset:1616
    v_mfma_f32_16x16x32_bf16 v[180:183], v[32:35], v[52:55], v[180:183]
    ds_read_b128 v[124:127], v15 offset:2112
    v_mfma_f32_16x16x32_bf16 v[184:187], v[24:27], v[64:67], v[184:187]
    ds_read_b64 v[96:97], v13 offset:2120
    ds_read_b64 v[98:99], v13 offset:2128
    v_mfma_f32_16x16x32_bf16 v[184:187], v[32:35], v[56:59], v[184:187]
    ds_read_b128 v[128:131], v15 offset:1600
    v_mfma_f32_16x16x32_bf16 v[188:191], v[28:31], v[64:67], 0
    ds_read_b64 v[100:101], v13 offset:2632
    v_mfma_f32_16x16x32_bf16 v[188:191], v[32:35], v[60:63], v[188:191]
    ds_read_b64 v[102:103], v13 offset:2640
    s_waitcnt lgkmcnt(14)
    v_mfma_f32_16x16x32_bf16 v[180:183], v[16:19], v[68:71], v[180:183]
    ds_read_b128 v[132:135], v15 offset:1088
    v_mfma_f32_16x16x32_bf16 v[180:183], v[36:39], v[48:51], v[180:183]
    ds_read_b64 v[104:105], v13 offset:3144
    ds_read_b64 v[106:107], v13 offset:3152
    v_mfma_f32_16x16x32_bf16 v[184:187], v[20:23], v[68:71], v[184:187]
    ds_read_b128 v[136:139], v15 offset:576
    v_mfma_f32_16x16x32_bf16 v[184:187], v[36:39], v[52:55], v[184:187]
    ds_read_b64 v[108:109], v13 offset:3656
    v_mfma_f32_16x16x32_bf16 v[188:191], v[24:27], v[68:71], v[188:191]
    ds_read_b64 v[110:111], v13 offset:3664
    v_mfma_f32_16x16x32_bf16 v[188:191], v[36:39], v[56:59], v[188:191]
    ds_read_b128 v[192:195], v15 offset:64
    s_waitcnt lgkmcnt(14)
    v_mfma_f32_16x16x32_bf16 v[184:187], v[16:19], v[72:75], v[184:187]
    v_mfma_f32_16x16x32_bf16 v[184:187], v[40:43], v[48:51], v[184:187]
    v_mfma_f32_16x16x32_bf16 v[188:191], v[20:23], v[72:75], v[188:191]
    v_mfma_f32_16x16x32_bf16 v[188:191], v[40:43], v[52:55], v[188:191]
    s_waitcnt lgkmcnt(14)
    v_mfma_f32_16x16x32_bf16 v[188:191], v[16:19], v[76:79], v[188:191]
    v_mfma_f32_16x16x32_bf16 v[188:191], v[44:47], v[48:51], v[188:191]
    s_waitcnt lgkmcnt(0)
    v_mfma_f32_16x16x32_bf16 v[160:163], v[80:83], v[112:115], v[160:163]
    ds_read_b64 v[16:17], v13 offset:136
    v_mfma_f32_16x16x32_bf16 v[164:167], v[80:83], v[116:119], v[164:167]
    ds_read_b64 v[18:19], v13 offset:144
    v_mfma_f32_16x16x32_bf16 v[164:167], v[84:87], v[112:115], v[164:167]
    ds_read_b128 v[48:51], v15 offset:3712
    v_mfma_f32_16x16x32_bf16 v[168:171], v[80:83], v[120:123], v[168:171]
    ds_read_b64 v[20:21], v13 offset:648
    v_mfma_f32_16x16x32_bf16 v[168:171], v[84:87], v[116:119], v[168:171]
    ds_read_b64 v[22:23], v13 offset:656
    v_mfma_f32_16x16x32_bf16 v[168:171], v[88:91], v[112:115], v[168:171]
    ds_read_b128 v[52:55], v15 offset:3200
    v_mfma_f32_16x16x32_bf16 v[172:175], v[80:83], v[124:127], v[172:175]
    ds_read_b64 v[24:25], v13 offset:1160
    v_mfma_f32_16x16x32_bf16 v[172:175], v[84:87], v[120:123], v[172:175]
    ds_read_b64 v[26:27], v13 offset:1168
    v_mfma_f32_16x16x32_bf16 v[172:175], v[88:91], v[116:119], v[172:175]
    ds_read_b128 v[56:59], v15 offset:2688
    v_mfma_f32_16x16x32_bf16 v[172:175], v[92:95], v[112:115], v[172:175]
    ds_read_b64 v[28:29], v13 offset:1672
    v_mfma_f32_16x16x32_bf16 v[176:179], v[80:83], v[128:131], v[176:179]
    ds_read_b64 v[30:31], v13 offset:1680
    v_mfma_f32_16x16x32_bf16 v[176:179], v[84:87], v[124:127], v[176:179]
    ds_read_b128 v[60:63], v15 offset:2176
    v_mfma_f32_16x16x32_bf16 v[176:179], v[88:91], v[120:123], v[176:179]
    ds_read_b64 v[32:33], v13 offset:2184
    v_mfma_f32_16x16x32_bf16 v[176:179], v[92:95], v[116:119], v[176:179]
    ds_read_b64 v[34:35], v13 offset:2192
    v_mfma_f32_16x16x32_bf16 v[176:179], v[96:99], v[112:115], v[176:179]
    ds_read_b128 v[64:67], v15 offset:1664
    v_mfma_f32_16x16x32_bf16 v[180:183], v[80:83], v[132:135], v[180:183]
    ds_read_b64 v[36:37], v13 offset:2696
    v_mfma_f32_16x16x32_bf16 v[180:183], v[84:87], v[128:131], v[180:183]
    ds_read_b64 v[38:39], v13 offset:2704
    v_mfma_f32_16x16x32_bf16 v[180:183], v[88:91], v[124:127], v[180:183]
    ds_read_b128 v[68:71], v15 offset:1152
    v_mfma_f32_16x16x32_bf16 v[180:183], v[92:95], v[120:123], v[180:183]
    ds_read_b64 v[40:41], v13 offset:3208
    v_mfma_f32_16x16x32_bf16 v[180:183], v[96:99], v[116:119], v[180:183]
    ds_read_b64 v[42:43], v13 offset:3216
    v_mfma_f32_16x16x32_bf16 v[180:183], v[100:103], v[112:115], v[180:183]
    ds_read_b128 v[72:75], v15 offset:640
    v_mfma_f32_16x16x32_bf16 v[184:187], v[80:83], v[136:139], v[184:187]
    ds_read_b64 v[44:45], v13 offset:3720
    v_mfma_f32_16x16x32_bf16 v[184:187], v[84:87], v[132:135], v[184:187]
    ds_read_b64 v[46:47], v13 offset:3728
    v_mfma_f32_16x16x32_bf16 v[184:187], v[88:91], v[128:131], v[184:187]
    ds_read_b128 v[76:79], v15 offset:128
    v_mfma_f32_16x16x32_bf16 v[184:187], v[92:95], v[124:127], v[184:187]
    v_mfma_f32_16x16x32_bf16 v[184:187], v[96:99], v[120:123], v[184:187]
    v_mfma_f32_16x16x32_bf16 v[184:187], v[100:103], v[116:119], v[184:187]
    v_mfma_f32_16x16x32_bf16 v[184:187], v[104:107], v[112:115], v[184:187]
    v_mfma_f32_16x16x32_bf16 v[188:191], v[80:83], v[192:195], v[188:191]
    v_mfma_f32_16x16x32_bf16 v[188:191], v[84:87], v[136:139], v[188:191]
    v_mfma_f32_16x16x32_bf16 v[188:191], v[88:91], v[132:135], v[188:191]
    v_mfma_f32_16x16x32_bf16 v[188:191], v[92:95], v[128:131], v[188:191]
    v_mfma_f32_16x16x32_bf16 v[188:191], v[96:99], v[124:127], v[188:191]
    v_mfma_f32_16x16x32_bf16 v[188:191], v[100:103], v[120:123], v[188:191]
    v_mfma_f32_16x16x32_bf16 v[188:191], v[104:107], v[116:119], v[188:191]
    v_mfma_f32_16x16x32_bf16 v[188:191], v[108:111], v[112:115], v[188:191]
    s_waitcnt lgkmcnt(0)
    v_mfma_f32_16x16x32_bf16 v[160:163], v[16:19], v[48:51], v[160:163]
    ds_read_b64 v[80:81], v13 offset:200
    v_mfma_f32_16x16x32_bf16 v[164:167], v[16:19], v[52:55], v[164:167]
    ds_read_b64 v[82:83], v13 offset:208
    v_mfma_f32_16x16x32_bf16 v[164:167], v[20:23], v[48:51], v[164:167]
    ds_read_b128 v[112:115], v15 offset:3776
    v_mfma_f32_16x16x32_bf16 v[168:171], v[16:19], v[56:59], v[168:171]
    ds_read_b64 v[84:85], v13 offset:712
    v_mfma_f32_16x16x32_bf16 v[168:171], v[20:23], v[52:55], v[168:171]
    ds_read_b64 v[86:87], v13 offset:720
    v_mfma_f32_16x16x32_bf16 v[168:171], v[24:27], v[48:51], v[168:171]
    ds_read_b128 v[116:119], v15 offset:3264
    v_mfma_f32_16x16x32_bf16 v[172:175], v[16:19], v[60:63], v[172:175]
    ds_read_b64 v[88:89], v13 offset:1224
    v_mfma_f32_16x16x32_bf16 v[172:175], v[20:23], v[56:59], v[172:175]
    ds_read_b64 v[90:91], v13 offset:1232
    v_mfma_f32_16x16x32_bf16 v[172:175], v[24:27], v[52:55], v[172:175]
    ds_read_b128 v[120:123], v15 offset:2752
    v_mfma_f32_16x16x32_bf16 v[172:175], v[28:31], v[48:51], v[172:175]
    ds_read_b64 v[92:93], v13 offset:1736
    v_mfma_f32_16x16x32_bf16 v[176:179], v[16:19], v[64:67], v[176:179]
    ds_read_b64 v[94:95], v13 offset:1744
    v_mfma_f32_16x16x32_bf16 v[176:179], v[20:23], v[60:63], v[176:179]
    ds_read_b128 v[124:127], v15 offset:2240
    v_mfma_f32_16x16x32_bf16 v[176:179], v[24:27], v[56:59], v[176:179]
    ds_read_b64 v[96:97], v13 offset:2248
    v_mfma_f32_16x16x32_bf16 v[176:179], v[28:31], v[52:55], v[176:179]
    ds_read_b64 v[98:99], v13 offset:2256
    v_mfma_f32_16x16x32_bf16 v[176:179], v[32:35], v[48:51], v[176:179]
    ds_read_b128 v[128:131], v15 offset:1728
    v_mfma_f32_16x16x32_bf16 v[180:183], v[16:19], v[68:71], v[180:183]
    ds_read_b64 v[100:101], v13 offset:2760
    v_mfma_f32_16x16x32_bf16 v[180:183], v[20:23], v[64:67], v[180:183]
    ds_read_b64 v[102:103], v13 offset:2768
    v_mfma_f32_16x16x32_bf16 v[180:183], v[24:27], v[60:63], v[180:183]
    ds_read_b128 v[132:135], v15 offset:1216
    v_mfma_f32_16x16x32_bf16 v[180:183], v[28:31], v[56:59], v[180:183]
    ds_read_b64 v[104:105], v13 offset:3272
    v_mfma_f32_16x16x32_bf16 v[180:183], v[32:35], v[52:55], v[180:183]
    ds_read_b64 v[106:107], v13 offset:3280
    v_mfma_f32_16x16x32_bf16 v[180:183], v[36:39], v[48:51], v[180:183]
    ds_read_b128 v[136:139], v15 offset:704
    v_mfma_f32_16x16x32_bf16 v[184:187], v[16:19], v[72:75], v[184:187]
    ds_read_b64 v[108:109], v13 offset:3784
    v_mfma_f32_16x16x32_bf16 v[184:187], v[20:23], v[68:71], v[184:187]
    ds_read_b64 v[110:111], v13 offset:3792
    v_mfma_f32_16x16x32_bf16 v[184:187], v[24:27], v[64:67], v[184:187]
    ds_read_b128 v[192:195], v15 offset:192
    v_mfma_f32_16x16x32_bf16 v[184:187], v[28:31], v[60:63], v[184:187]
    v_mfma_f32_16x16x32_bf16 v[184:187], v[32:35], v[56:59], v[184:187]
    v_mfma_f32_16x16x32_bf16 v[184:187], v[36:39], v[52:55], v[184:187]
    v_mfma_f32_16x16x32_bf16 v[184:187], v[40:43], v[48:51], v[184:187]
    v_mfma_f32_16x16x32_bf16 v[188:191], v[16:19], v[76:79], v[188:191]
    v_mfma_f32_16x16x32_bf16 v[188:191], v[20:23], v[72:75], v[188:191]
    v_mfma_f32_16x16x32_bf16 v[188:191], v[24:27], v[68:71], v[188:191]
    v_mfma_f32_16x16x32_bf16 v[188:191], v[28:31], v[64:67], v[188:191]
    v_mfma_f32_16x16x32_bf16 v[188:191], v[32:35], v[60:63], v[188:191]
    v_mfma_f32_16x16x32_bf16 v[188:191], v[36:39], v[56:59], v[188:191]
    v_mfma_f32_16x16x32_bf16 v[188:191], v[40:43], v[52:55], v[188:191]
    v_mfma_f32_16x16x32_bf16 v[188:191], v[44:47], v[48:51], v[188:191]
    s_waitcnt lgkmcnt(0)
    v_mfma_f32_16x16x32_bf16 v[160:163], v[80:83], v[112:115], v[160:163]
    ds_read_b64 v[16:17], v13 offset:264
    v_mfma_f32_16x16x32_bf16 v[164:167], v[80:83], v[116:119], v[164:167]
    ds_read_b64 v[18:19], v13 offset:272
    v_mfma_f32_16x16x32_bf16 v[164:167], v[84:87], v[112:115], v[164:167]
    ds_read_b128 v[48:51], v15 offset:3840
    v_mfma_f32_16x16x32_bf16 v[168:171], v[80:83], v[120:123], v[168:171]
    ds_read_b64 v[20:21], v13 offset:776
    v_mfma_f32_16x16x32_bf16 v[168:171], v[84:87], v[116:119], v[168:171]
    ds_read_b64 v[22:23], v13 offset:784
    v_mfma_f32_16x16x32_bf16 v[168:171], v[88:91], v[112:115], v[168:171]
    ds_read_b128 v[52:55], v15 offset:3328
    v_mfma_f32_16x16x32_bf16 v[172:175], v[80:83], v[124:127], v[172:175]
    ds_read_b64 v[24:25], v13 offset:1288
    v_mfma_f32_16x16x32_bf16 v[172:175], v[84:87], v[120:123], v[172:175]
    ds_read_b64 v[26:27], v13 offset:1296
    v_mfma_f32_16x16x32_bf16 v[172:175], v[88:91], v[116:119], v[172:175]
    ds_read_b128 v[56:59], v15 offset:2816
    v_mfma_f32_16x16x32_bf16 v[172:175], v[92:95], v[112:115], v[172:175]
    ds_read_b64 v[28:29], v13 offset:1800
    v_mfma_f32_16x16x32_bf16 v[176:179], v[80:83], v[128:131], v[176:179]
    ds_read_b64 v[30:31], v13 offset:1808
    v_mfma_f32_16x16x32_bf16 v[176:179], v[84:87], v[124:127], v[176:179]
    ds_read_b128 v[60:63], v15 offset:2304
    v_mfma_f32_16x16x32_bf16 v[176:179], v[88:91], v[120:123], v[176:179]
    ds_read_b64 v[32:33], v13 offset:2312
    v_mfma_f32_16x16x32_bf16 v[176:179], v[92:95], v[116:119], v[176:179]
    ds_read_b64 v[34:35], v13 offset:2320
    v_mfma_f32_16x16x32_bf16 v[176:179], v[96:99], v[112:115], v[176:179]
    ds_read_b128 v[64:67], v15 offset:1792
    v_mfma_f32_16x16x32_bf16 v[180:183], v[80:83], v[132:135], v[180:183]
    ds_read_b64 v[36:37], v13 offset:2824
    v_mfma_f32_16x16x32_bf16 v[180:183], v[84:87], v[128:131], v[180:183]
    ds_read_b64 v[38:39], v13 offset:2832
    v_mfma_f32_16x16x32_bf16 v[180:183], v[88:91], v[124:127], v[180:183]
    ds_read_b128 v[68:71], v15 offset:1280
    v_mfma_f32_16x16x32_bf16 v[180:183], v[92:95], v[120:123], v[180:183]
    ds_read_b64 v[40:41], v13 offset:3336
    v_mfma_f32_16x16x32_bf16 v[180:183], v[96:99], v[116:119], v[180:183]
    ds_read_b64 v[42:43], v13 offset:3344
    v_mfma_f32_16x16x32_bf16 v[180:183], v[100:103], v[112:115], v[180:183]
    ds_read_b128 v[72:75], v15 offset:768
    v_mfma_f32_16x16x32_bf16 v[184:187], v[80:83], v[136:139], v[184:187]
    ds_read_b64 v[44:45], v13 offset:3848
    v_mfma_f32_16x16x32_bf16 v[184:187], v[84:87], v[132:135], v[184:187]
    ds_read_b64 v[46:47], v13 offset:3856
    v_mfma_f32_16x16x32_bf16 v[184:187], v[88:91], v[128:131], v[184:187]
    ds_read_b128 v[76:79], v15 offset:256
    v_mfma_f32_16x16x32_bf16 v[184:187], v[92:95], v[124:127], v[184:187]
    v_mfma_f32_16x16x32_bf16 v[184:187], v[96:99], v[120:123], v[184:187]
    v_mfma_f32_16x16x32_bf16 v[184:187], v[100:103], v[116:119], v[184:187]
    v_mfma_f32_16x16x32_bf16 v[184:187], v[104:107], v[112:115], v[184:187]
    v_mfma_f32_16x16x32_bf16 v[188:191], v[80:83], v[192:195], v[188:191]
    v_mfma_f32_16x16x32_bf16 v[188:191], v[84:87], v[136:139], v[188:191]
    v_mfma_f32_16x16x32_bf16 v[188:191], v[88:91], v[132:135], v[188:191]
    v_mfma_f32_16x16x32_bf16 v[188:191], v[92:95], v[128:131], v[188:191]
    v_mfma_f32_16x16x32_bf16 v[188:191], v[96:99], v[124:127], v[188:191]
    v_mfma_f32_16x16x32_bf16 v[188:191], v[100:103], v[120:123], v[188:191]
    v_mfma_f32_16x16x32_bf16 v[188:191], v[104:107], v[116:119], v[188:191]
    v_mfma_f32_16x16x32_bf16 v[188:191], v[108:111], v[112:115], v[188:191]
    s_waitcnt lgkmcnt(0)
    v_mfma_f32_16x16x32_bf16 v[160:163], v[16:19], v[48:51], v[160:163]
    ds_read_b64 v[80:81], v13 offset:328
    v_mfma_f32_16x16x32_bf16 v[164:167], v[16:19], v[52:55], v[164:167]
    ds_read_b64 v[82:83], v13 offset:336
    v_mfma_f32_16x16x32_bf16 v[164:167], v[20:23], v[48:51], v[164:167]
    ds_read_b128 v[112:115], v15 offset:3904
    v_mfma_f32_16x16x32_bf16 v[168:171], v[16:19], v[56:59], v[168:171]
    ds_read_b64 v[84:85], v13 offset:840
    v_mfma_f32_16x16x32_bf16 v[168:171], v[20:23], v[52:55], v[168:171]
    ds_read_b64 v[86:87], v13 offset:848
    v_mfma_f32_16x16x32_bf16 v[168:171], v[24:27], v[48:51], v[168:171]
    ds_read_b128 v[116:119], v15 offset:3392
    v_mfma_f32_16x16x32_bf16 v[172:175], v[16:19], v[60:63], v[172:175]
    ds_read_b64 v[88:89], v13 offset:1352
    v_mfma_f32_16x16x32_bf16 v[172:175], v[20:23], v[56:59], v[172:175]
    ds_read_b64 v[90:91], v13 offset:1360
    v_mfma_f32_16x16x32_bf16 v[172:175], v[24:27], v[52:55], v[172:175]
    ds_read_b128 v[120:123], v15 offset:2880
    v_mfma_f32_16x16x32_bf16 v[172:175], v[28:31], v[48:51], v[172:175]
    ds_read_b64 v[92:93], v13 offset:1864
    v_mfma_f32_16x16x32_bf16 v[176:179], v[16:19], v[64:67], v[176:179]
    ds_read_b64 v[94:95], v13 offset:1872
    v_mfma_f32_16x16x32_bf16 v[176:179], v[20:23], v[60:63], v[176:179]
    ds_read_b128 v[124:127], v15 offset:2368
    v_mfma_f32_16x16x32_bf16 v[176:179], v[24:27], v[56:59], v[176:179]
    ds_read_b64 v[96:97], v13 offset:2376
    v_mfma_f32_16x16x32_bf16 v[176:179], v[28:31], v[52:55], v[176:179]
    ds_read_b64 v[98:99], v13 offset:2384
    v_mfma_f32_16x16x32_bf16 v[176:179], v[32:35], v[48:51], v[176:179]
    ds_read_b128 v[128:131], v15 offset:1856
    v_mfma_f32_16x16x32_bf16 v[180:183], v[16:19], v[68:71], v[180:183]
    ds_read_b64 v[100:101], v13 offset:2888
    v_mfma_f32_16x16x32_bf16 v[180:183], v[20:23], v[64:67], v[180:183]
    ds_read_b64 v[102:103], v13 offset:2896
    v_mfma_f32_16x16x32_bf16 v[180:183], v[24:27], v[60:63], v[180:183]
    ds_read_b128 v[132:135], v15 offset:1344
    v_mfma_f32_16x16x32_bf16 v[180:183], v[28:31], v[56:59], v[180:183]
    ds_read_b64 v[104:105], v13 offset:3400
    v_mfma_f32_16x16x32_bf16 v[180:183], v[32:35], v[52:55], v[180:183]
    ds_read_b64 v[106:107], v13 offset:3408
    v_mfma_f32_16x16x32_bf16 v[180:183], v[36:39], v[48:51], v[180:183]
    ds_read_b128 v[136:139], v15 offset:832
    v_mfma_f32_16x16x32_bf16 v[184:187], v[16:19], v[72:75], v[184:187]
    ds_read_b64 v[108:109], v13 offset:3912
    v_mfma_f32_16x16x32_bf16 v[184:187], v[20:23], v[68:71], v[184:187]
    ds_read_b64 v[110:111], v13 offset:3920
    v_mfma_f32_16x16x32_bf16 v[184:187], v[24:27], v[64:67], v[184:187]
    ds_read_b128 v[192:195], v15 offset:320
    v_mfma_f32_16x16x32_bf16 v[184:187], v[28:31], v[60:63], v[184:187]
    v_mfma_f32_16x16x32_bf16 v[184:187], v[32:35], v[56:59], v[184:187]
    v_mfma_f32_16x16x32_bf16 v[184:187], v[36:39], v[52:55], v[184:187]
    v_mfma_f32_16x16x32_bf16 v[184:187], v[40:43], v[48:51], v[184:187]
    v_mfma_f32_16x16x32_bf16 v[188:191], v[16:19], v[76:79], v[188:191]
    v_mfma_f32_16x16x32_bf16 v[188:191], v[20:23], v[72:75], v[188:191]
    v_mfma_f32_16x16x32_bf16 v[188:191], v[24:27], v[68:71], v[188:191]
    v_mfma_f32_16x16x32_bf16 v[188:191], v[28:31], v[64:67], v[188:191]
    v_mfma_f32_16x16x32_bf16 v[188:191], v[32:35], v[60:63], v[188:191]
    v_mfma_f32_16x16x32_bf16 v[188:191], v[36:39], v[56:59], v[188:191]
    v_mfma_f32_16x16x32_bf16 v[188:191], v[40:43], v[52:55], v[188:191]
    v_mfma_f32_16x16x32_bf16 v[188:191], v[44:47], v[48:51], v[188:191]
    s_waitcnt lgkmcnt(0)
    v_mfma_f32_16x16x32_bf16 v[160:163], v[80:83], v[112:115], v[160:163]
    ds_read_b64 v[16:17], v13 offset:392
    v_mfma_f32_16x16x32_bf16 v[164:167], v[80:83], v[116:119], v[164:167]
    ds_read_b64 v[18:19], v13 offset:400
    v_mfma_f32_16x16x32_bf16 v[164:167], v[84:87], v[112:115], v[164:167]
    ds_read_b128 v[48:51], v15 offset:3968
    v_mfma_f32_16x16x32_bf16 v[168:171], v[80:83], v[120:123], v[168:171]
    ds_read_b64 v[20:21], v13 offset:904
    v_mfma_f32_16x16x32_bf16 v[168:171], v[84:87], v[116:119], v[168:171]
    ds_read_b64 v[22:23], v13 offset:912
    v_mfma_f32_16x16x32_bf16 v[168:171], v[88:91], v[112:115], v[168:171]
    ds_read_b128 v[52:55], v15 offset:3456
    v_mfma_f32_16x16x32_bf16 v[172:175], v[80:83], v[124:127], v[172:175]
    ds_read_b64 v[24:25], v13 offset:1416
    v_mfma_f32_16x16x32_bf16 v[172:175], v[84:87], v[120:123], v[172:175]
    ds_read_b64 v[26:27], v13 offset:1424
    v_mfma_f32_16x16x32_bf16 v[172:175], v[88:91], v[116:119], v[172:175]
    ds_read_b128 v[56:59], v15 offset:2944
    v_mfma_f32_16x16x32_bf16 v[172:175], v[92:95], v[112:115], v[172:175]
    ds_read_b64 v[28:29], v13 offset:1928
    v_mfma_f32_16x16x32_bf16 v[176:179], v[80:83], v[128:131], v[176:179]
    ds_read_b64 v[30:31], v13 offset:1936
    v_mfma_f32_16x16x32_bf16 v[176:179], v[84:87], v[124:127], v[176:179]
    ds_read_b128 v[60:63], v15 offset:2432
    v_mfma_f32_16x16x32_bf16 v[176:179], v[88:91], v[120:123], v[176:179]
    ds_read_b64 v[32:33], v13 offset:2440
    v_mfma_f32_16x16x32_bf16 v[176:179], v[92:95], v[116:119], v[176:179]
    ds_read_b64 v[34:35], v13 offset:2448
    v_mfma_f32_16x16x32_bf16 v[176:179], v[96:99], v[112:115], v[176:179]
    ds_read_b128 v[64:67], v15 offset:1920
    v_mfma_f32_16x16x32_bf16 v[180:183], v[80:83], v[132:135], v[180:183]
    ds_read_b64 v[36:37], v13 offset:2952
    v_mfma_f32_16x16x32_bf16 v[180:183], v[84:87], v[128:131], v[180:183]
    ds_read_b64 v[38:39], v13 offset:2960
    v_mfma_f32_16x16x32_bf16 v[180:183], v[88:91], v[124:127], v[180:183]
    ds_read_b128 v[68:71], v15 offset:1408
    v_mfma_f32_16x16x32_bf16 v[180:183], v[92:95], v[120:123], v[180:183]
    ds_read_b64 v[40:41], v13 offset:3464
    v_mfma_f32_16x16x32_bf16 v[180:183], v[96:99], v[116:119], v[180:183]
    ds_read_b64 v[42:43], v13 offset:3472
    v_mfma_f32_16x16x32_bf16 v[180:183], v[100:103], v[112:115], v[180:183]
    ds_read_b128 v[72:75], v15 offset:896
    v_mfma_f32_16x16x32_bf16 v[184:187], v[80:83], v[136:139], v[184:187]
    ds_read_b64 v[44:45], v13 offset:3976
    v_mfma_f32_16x16x32_bf16 v[184:187], v[84:87], v[132:135], v[184:187]
    ds_read_b64 v[46:47], v13 offset:3984
    v_mfma_f32_16x16x32_bf16 v[184:187], v[88:91], v[128:131], v[184:187]
    ds_read_b128 v[76:79], v15 offset:384
    v_mfma_f32_16x16x32_bf16 v[184:187], v[92:95], v[124:127], v[184:187]
    v_mfma_f32_16x16x32_bf16 v[184:187], v[96:99], v[120:123], v[184:187]
    v_mfma_f32_16x16x32_bf16 v[184:187], v[100:103], v[116:119], v[184:187]
    v_mfma_f32_16x16x32_bf16 v[184:187], v[104:107], v[112:115], v[184:187]
    v_mfma_f32_16x16x32_bf16 v[188:191], v[80:83], v[192:195], v[188:191]
    v_mfma_f32_16x16x32_bf16 v[188:191], v[84:87], v[136:139], v[188:191]
    v_mfma_f32_16x16x32_bf16 v[188:191], v[88:91], v[132:135], v[188:191]
    v_mfma_f32_16x16x32_bf16 v[188:191], v[92:95], v[128:131], v[188:191]
    v_mfma_f32_16x16x32_bf16 v[188:191], v[96:99], v[124:127], v[188:191]
    v_mfma_f32_16x16x32_bf16 v[188:191], v[100:103], v[120:123], v[188:191]
    v_mfma_f32_16x16x32_bf16 v[188:191], v[104:107], v[116:119], v[188:191]
    v_mfma_f32_16x16x32_bf16 v[188:191], v[108:111], v[112:115], v[188:191]
    s_waitcnt lgkmcnt(0)
    v_mfma_f32_16x16x32_bf16 v[160:163], v[16:19], v[48:51], v[160:163]
    ds_read_b64 v[80:81], v13 offset:456
    v_mfma_f32_16x16x32_bf16 v[164:167], v[16:19], v[52:55], v[164:167]
    ds_read_b64 v[82:83], v13 offset:464
    v_mfma_f32_16x16x32_bf16 v[164:167], v[20:23], v[48:51], v[164:167]
    ds_read_b128 v[112:115], v15 offset:4032
    v_mfma_f32_16x16x32_bf16 v[168:171], v[16:19], v[56:59], v[168:171]
    ds_read_b64 v[84:85], v13 offset:968
    v_mfma_f32_16x16x32_bf16 v[168:171], v[20:23], v[52:55], v[168:171]
    ds_read_b64 v[86:87], v13 offset:976
    v_mfma_f32_16x16x32_bf16 v[168:171], v[24:27], v[48:51], v[168:171]
    ds_read_b128 v[116:119], v15 offset:3520
    v_mfma_f32_16x16x32_bf16 v[172:175], v[16:19], v[60:63], v[172:175]
    ds_read_b64 v[88:89], v13 offset:1480
    v_mfma_f32_16x16x32_bf16 v[172:175], v[20:23], v[56:59], v[172:175]
    ds_read_b64 v[90:91], v13 offset:1488
    v_mfma_f32_16x16x32_bf16 v[172:175], v[24:27], v[52:55], v[172:175]
    ds_read_b128 v[120:123], v15 offset:3008
    v_mfma_f32_16x16x32_bf16 v[172:175], v[28:31], v[48:51], v[172:175]
    ds_read_b64 v[92:93], v13 offset:1992
    v_mfma_f32_16x16x32_bf16 v[176:179], v[16:19], v[64:67], v[176:179]
    ds_read_b64 v[94:95], v13 offset:2000
    v_mfma_f32_16x16x32_bf16 v[176:179], v[20:23], v[60:63], v[176:179]
    ds_read_b128 v[124:127], v15 offset:2496
    v_mfma_f32_16x16x32_bf16 v[176:179], v[24:27], v[56:59], v[176:179]
    ds_read_b64 v[96:97], v13 offset:2504
    v_mfma_f32_16x16x32_bf16 v[176:179], v[28:31], v[52:55], v[176:179]
    ds_read_b64 v[98:99], v13 offset:2512
    v_mfma_f32_16x16x32_bf16 v[176:179], v[32:35], v[48:51], v[176:179]
    ds_read_b128 v[128:131], v15 offset:1984
    v_mfma_f32_16x16x32_bf16 v[180:183], v[16:19], v[68:71], v[180:183]
    ds_read_b64 v[100:101], v13 offset:3016
    v_mfma_f32_16x16x32_bf16 v[180:183], v[20:23], v[64:67], v[180:183]
    ds_read_b64 v[102:103], v13 offset:3024
    v_mfma_f32_16x16x32_bf16 v[180:183], v[24:27], v[60:63], v[180:183]
    ds_read_b128 v[132:135], v15 offset:1472
    v_mfma_f32_16x16x32_bf16 v[180:183], v[28:31], v[56:59], v[180:183]
    ds_read_b64 v[104:105], v13 offset:3528
    v_mfma_f32_16x16x32_bf16 v[180:183], v[32:35], v[52:55], v[180:183]
    ds_read_b64 v[106:107], v13 offset:3536
    v_mfma_f32_16x16x32_bf16 v[180:183], v[36:39], v[48:51], v[180:183]
    ds_read_b128 v[136:139], v15 offset:960
    v_mfma_f32_16x16x32_bf16 v[184:187], v[16:19], v[72:75], v[184:187]
    ds_read_b64 v[108:109], v13 offset:4040
    v_mfma_f32_16x16x32_bf16 v[184:187], v[20:23], v[68:71], v[184:187]
    ds_read_b64 v[110:111], v13 offset:4048
    v_mfma_f32_16x16x32_bf16 v[184:187], v[24:27], v[64:67], v[184:187]
    ds_read_b128 v[192:195], v15 offset:448
    v_mfma_f32_16x16x32_bf16 v[184:187], v[28:31], v[60:63], v[184:187]
    v_mfma_f32_16x16x32_bf16 v[184:187], v[32:35], v[56:59], v[184:187]
    v_mfma_f32_16x16x32_bf16 v[184:187], v[36:39], v[52:55], v[184:187]
    v_mfma_f32_16x16x32_bf16 v[184:187], v[40:43], v[48:51], v[184:187]
    v_mfma_f32_16x16x32_bf16 v[188:191], v[16:19], v[76:79], v[188:191]
    v_mfma_f32_16x16x32_bf16 v[188:191], v[20:23], v[72:75], v[188:191]
    v_mfma_f32_16x16x32_bf16 v[188:191], v[24:27], v[68:71], v[188:191]
    v_mfma_f32_16x16x32_bf16 v[188:191], v[28:31], v[64:67], v[188:191]
    v_mfma_f32_16x16x32_bf16 v[188:191], v[32:35], v[60:63], v[188:191]
    v_mfma_f32_16x16x32_bf16 v[188:191], v[36:39], v[56:59], v[188:191]
    v_mfma_f32_16x16x32_bf16 v[188:191], v[40:43], v[52:55], v[188:191]
    v_mfma_f32_16x16x32_bf16 v[188:191], v[44:47], v[48:51], v[188:191]
    s_waitcnt lgkmcnt(0)
    v_mfma_f32_16x16x32_bf16 v[160:163], v[80:83], v[112:115], v[160:163]
    v_mfma_f32_16x16x32_bf16 v[164:167], v[80:83], v[116:119], v[164:167]
    v_mfma_f32_16x16x32_bf16 v[164:167], v[84:87], v[112:115], v[164:167]
    v_mfma_f32_16x16x32_bf16 v[168:171], v[80:83], v[120:123], v[168:171]
    v_mfma_f32_16x16x32_bf16 v[168:171], v[84:87], v[116:119], v[168:171]
    v_mfma_f32_16x16x32_bf16 v[168:171], v[88:91], v[112:115], v[168:171]
    v_mfma_f32_16x16x32_bf16 v[172:175], v[80:83], v[124:127], v[172:175]
    v_mfma_f32_16x16x32_bf16 v[172:175], v[84:87], v[120:123], v[172:175]
    v_mfma_f32_16x16x32_bf16 v[172:175], v[88:91], v[116:119], v[172:175]
    v_mfma_f32_16x16x32_bf16 v[172:175], v[92:95], v[112:115], v[172:175]
    v_mfma_f32_16x16x32_bf16 v[176:179], v[80:83], v[128:131], v[176:179]
    v_mfma_f32_16x16x32_bf16 v[176:179], v[84:87], v[124:127], v[176:179]
    v_mfma_f32_16x16x32_bf16 v[176:179], v[88:91], v[120:123], v[176:179]
    v_mfma_f32_16x16x32_bf16 v[176:179], v[92:95], v[116:119], v[176:179]
    v_mfma_f32_16x16x32_bf16 v[176:179], v[96:99], v[112:115], v[176:179]
    v_mfma_f32_16x16x32_bf16 v[180:183], v[80:83], v[132:135], v[180:183]
    v_mfma_f32_16x16x32_bf16 v[180:183], v[84:87], v[128:131], v[180:183]
    v_mfma_f32_16x16x32_bf16 v[180:183], v[88:91], v[124:127], v[180:183]
    v_mfma_f32_16x16x32_bf16 v[180:183], v[92:95], v[120:123], v[180:183]
    v_cvt_pk_bf16_f32 v16, v160, v161
    v_mfma_f32_16x16x32_bf16 v[180:183], v[96:99], v[116:119], v[180:183]
    v_cvt_pk_bf16_f32 v17, v162, v163
    v_mfma_f32_16x16x32_bf16 v[180:183], v[100:103], v[112:115], v[180:183]
    ds_write_b64 v158, v[16:17] offset:0
    v_mfma_f32_16x16x32_bf16 v[184:187], v[80:83], v[136:139], v[184:187]
    v_cvt_pk_bf16_f32 v18, v164, v165
    v_mfma_f32_16x16x32_bf16 v[184:187], v[84:87], v[132:135], v[184:187]
    v_cvt_pk_bf16_f32 v19, v166, v167
    v_mfma_f32_16x16x32_bf16 v[184:187], v[88:91], v[128:131], v[184:187]
    ds_write_b64 v158, v[18:19] offset:512
    v_mfma_f32_16x16x32_bf16 v[184:187], v[92:95], v[124:127], v[184:187]
    v_cvt_pk_bf16_f32 v20, v168, v169
    v_mfma_f32_16x16x32_bf16 v[184:187], v[96:99], v[120:123], v[184:187]
    v_cvt_pk_bf16_f32 v21, v170, v171
    v_mfma_f32_16x16x32_bf16 v[184:187], v[100:103], v[116:119], v[184:187]
    ds_write_b64 v158, v[20:21] offset:1024
    v_mfma_f32_16x16x32_bf16 v[184:187], v[104:107], v[112:115], v[184:187]
    v_cvt_pk_bf16_f32 v22, v172, v173
    v_mfma_f32_16x16x32_bf16 v[188:191], v[80:83], v[192:195], v[188:191]
    v_cvt_pk_bf16_f32 v23, v174, v175
    v_mfma_f32_16x16x32_bf16 v[188:191], v[84:87], v[136:139], v[188:191]
    ds_write_b64 v158, v[22:23] offset:1536
    v_mfma_f32_16x16x32_bf16 v[188:191], v[88:91], v[132:135], v[188:191]
    v_cvt_pk_bf16_f32 v24, v176, v177
    v_mfma_f32_16x16x32_bf16 v[188:191], v[92:95], v[128:131], v[188:191]
    v_cvt_pk_bf16_f32 v25, v178, v179
    v_mfma_f32_16x16x32_bf16 v[188:191], v[96:99], v[124:127], v[188:191]
    ds_write_b64 v158, v[24:25] offset:2048
    v_mfma_f32_16x16x32_bf16 v[188:191], v[100:103], v[120:123], v[188:191]
    v_cvt_pk_bf16_f32 v26, v180, v181
    v_mfma_f32_16x16x32_bf16 v[188:191], v[104:107], v[116:119], v[188:191]
    v_cvt_pk_bf16_f32 v27, v182, v183
    v_mfma_f32_16x16x32_bf16 v[188:191], v[108:111], v[112:115], v[188:191]
    ds_write_b64 v158, v[26:27] offset:2560
    v_cvt_pk_bf16_f32 v28, v184, v185
    v_cvt_pk_bf16_f32 v29, v186, v187
    ds_write_b64 v158, v[28:29] offset:3072
    s_nop 4
    v_cvt_pk_bf16_f32 v30, v188, v189
    v_cvt_pk_bf16_f32 v31, v190, v191
    ds_write_b64 v158, v[30:31] offset:3584
    s_setprio 0
    s_branch L_k2_join
L_k2_exit:
    s_endpgm
L_k2_bg:
    s_cmp_eq_u32 s25, 7
    s_cbranch_scc0 L_k2_noep
    v_mov_b32 v48, s13
    v_mov_b32 v49, 32768
    s_mov_b64 exec, 1
    buffer_store_dword v48, v49, s[56:59], 0 offen sc1
    s_mov_b64 exec, -1
L_k2_noep:
    s_cmp_ge_u32 s2, 224
    s_cbranch_scc1 L_k2_xb
    buffer_load_dwordx4 v[84:87], v15, s[84:87], s35 offen
    s_add_u32 s35, s35, 57344
    buffer_load_dwordx4 v[88:91], v15, s[84:87], s35 offen
    s_add_u32 s35, s35, 57344
    buffer_load_dwordx4 v[92:95], v15, s[84:87], s35 offen
    s_add_u32 s35, s35, 57344
    buffer_load_dwordx4 v[96:99], v15, s[84:87], s35 offen
    s_add_u32 s35, s35, 57344
    buffer_load_dwordx4 v[100:103], v15, s[84:87], s35 offen
    s_add_u32 s35, s35, 57344
    buffer_load_dwordx4 v[104:107], v15, s[84:87], s35 offen
    s_add_u32 s35, s35, 57344
    buffer_load_dwordx4 v[108:111], v15, s[84:87], s35 offen
    s_add_u32 s35, s35, 57344
    buffer_load_dwordx4 v[112:115], v15, s[84:87], s35 offen
    s_add_u32 s35, s35, 57344
    buffer_load_dwordx4 v[116:119], v15, s[84:87], s35 offen
    s_add_u32 s35, s35, 57344
    buffer_load_dwordx4 v[120:123], v15, s[84:87], s35 offen
    s_add_u32 s35, s35, 57344
    buffer_load_dwordx4 v[124:127], v15, s[84:87], s35 offen
    s_waitcnt vmcnt(15)
    v_lshlrev_b32 v48, 16, v212
    v_and_b32 v49, s47, v212
    v_lshlrev_b32 v50, 16, v213
    v_and_b32 v51, s47, v213
    v_lshlrev_b32 v52, 16, v214
    v_and_b32 v53, s47, v214
    v_lshlrev_b32 v54, 16, v215
    v_and_b32 v55, s47, v215
    s_waitcnt vmcnt(14)
    v_lshlrev_b32 v56, 16, v216
    v_and_b32 v57, s47, v216
    v_lshlrev_b32 v58, 16, v217
    v_and_b32 v59, s47, v217
    v_lshlrev_b32 v60, 16, v218
    v_and_b32 v61, s47, v218
    v_lshlrev_b32 v62, 16, v219
    v_and_b32 v63, s47, v219
    v_add_f32 v48, v48, v56
    v_add_f32 v49, v49, v57
    v_add_f32 v50, v50, v58
    v_add_f32 v51, v51, v59
    v_add_f32 v52, v52, v60
    v_add_f32 v53, v53, v61
    v_add_f32 v54, v54, v62
    v_add_f32 v55, v55, v63
    s_waitcnt vmcnt(13)
    v_lshlrev_b32 v56, 16, v220
    v_and_b32 v57, s47, v220
    v_lshlrev_b32 v58, 16, v221
    v_and_b32 v59, s47, v221
    v_lshlrev_b32 v60, 16, v222
    v_and_b32 v61, s47, v222
    v_lshlrev_b32 v62, 16, v223
    v_and_b32 v63, s47, v223
    v_add_f32 v48, v48, v56
    v_add_f32 v49, v49, v57
    v_add_f32 v50, v50, v58
    v_add_f32 v51, v51, v59
    v_add_f32 v52, v52, v60
    v_add_f32 v53, v53, v61
    v_add_f32 v54, v54, v62
    v_add_f32 v55, v55, v63
    s_waitcnt vmcnt(12)
    v_lshlrev_b32 v56, 16, v224
    v_and_b32 v57, s47, v224
    v_lshlrev_b32 v58, 16, v225
    v_and_b32 v59, s47, v225
    v_lshlrev_b32 v60, 16, v226
    v_and_b32 v61, s47, v226
    v_lshlrev_b32 v62, 16, v227
    v_and_b32 v63, s47, v227
    v_add_f32 v48, v48, v56
    v_add_f32 v49, v49, v57
    v_add_f32 v50, v50, v58
    v_add_f32 v51, v51, v59
    v_add_f32 v52, v52, v60
    v_add_f32 v53, v53, v61
    v_add_f32 v54, v54, v62
    v_add_f32 v55, v55, v63
    s_waitcnt vmcnt(11)
    v_lshlrev_b32 v56, 16, v228
    v_and_b32 v57, s47, v228
    v_lshlrev_b32 v58, 16, v229
    v_and_b32 v59, s47, v229
    v_lshlrev_b32 v60, 16, v230
    v_and_b32 v61, s47, v230
    v_lshlrev_b32 v62, 16, v231
    v_and_b32 v63, s47, v231
    v_add_f32 v48, v48, v56
    v_add_f32 v49, v49, v57
    v_add_f32 v50, v50, v58
    v_add_f32 v51, v51, v59
    v_add_f32 v52, v52, v60
    v_add_f32 v53, v53, v61
    v_add_f32 v54, v54, v62
    v_add_f32 v55, v55, v63
    s_waitcnt vmcnt(10)
    v_lshlrev_b32 v56, 16, v84
    v_and_b32 v57, s47, v84
    v_lshlrev_b32 v58, 16, v85
    v_and_b32 v59, s47, v85
    v_lshlrev_b32 v60, 16, v86
    v_and_b32 v61, s47, v86
    v_lshlrev_b32 v62, 16, v87
    v_and_b32 v63, s47, v87
    v_add_f32 v48, v48, v56
    v_add_f32 v49, v49, v57
    v_add_f32 v50, v50, v58
    v_add_f32 v51, v51, v59
    v_add_f32 v52, v52, v60
    v_add_f32 v53, v53, v61
    v_add_f32 v54, v54, v62
    v_add_f32 v55, v55, v63
    s_waitcnt vmcnt(9)
    v_lshlrev_b32 v56, 16, v88
    v_and_b32 v57, s47, v88
    v_lshlrev_b32 v58, 16, v89
    v_and_b32 v59, s47, v89
    v_lshlrev_b32 v60, 16, v90
    v_and_b32 v61, s47, v90
    v_lshlrev_b32 v62, 16, v91
    v_and_b32 v63, s47, v91
    v_add_f32 v48, v48, v56
    v_add_f32 v49, v49, v57
    v_add_f32 v50, v50, v58
    v_add_f32 v51, v51, v59
    v_add_f32 v52, v52, v60
    v_add_f32 v53, v53, v61
    v_add_f32 v54, v54, v62
    v_add_f32 v55, v55, v63
    s_waitcnt vmcnt(8)
    v_lshlrev_b32 v56, 16, v92
    v_and_b32 v57, s47, v92
    v_lshlrev_b32 v58, 16, v93
    v_and_b32 v59, s47, v93
    v_lshlrev_b32 v60, 16, v94
    v_and_b32 v61, s47, v94
    v_lshlrev_b32 v62, 16, v95
    v_and_b32 v63, s47, v95
    v_add_f32 v48, v48, v56
    v_add_f32 v49, v49, v57
    v_add_f32 v50, v50, v58
    v_add_f32 v51, v51, v59
    v_add_f32 v52, v52, v60
    v_add_f32 v53, v53, v61
    v_add_f32 v54, v54, v62
    v_add_f32 v55, v55, v63
    s_waitcnt vmcnt(7)
    v_lshlrev_b32 v56, 16, v96
    v_and_b32 v57, s47, v96
    v_lshlrev_b32 v58, 16, v97
    v_and_b32 v59, s47, v97
    v_lshlrev_b32 v60, 16, v98
    v_and_b32 v61, s47, v98
    v_lshlrev_b32 v62, 16, v99
    v_and_b32 v63, s47, v99
    v_add_f32 v48, v48, v56
    v_add_f32 v49, v49, v57
    v_add_f32 v50, v50, v58
    v_add_f32 v51, v51, v59
    v_add_f32 v52, v52, v60
    v_add_f32 v53, v53, v61
    v_add_f32 v54, v54, v62
    v_add_f32 v55, v55, v63
    s_waitcnt vmcnt(6)
    v_lshlrev_b32 v56, 16, v100
    v_and_b32 v57, s47, v100
    v_lshlrev_b32 v58, 16, v101
    v_and_b32 v59, s47, v101
    v_lshlrev_b32 v60, 16, v102
    v_and_b32 v61, s47, v102
    v_lshlrev_b32 v62, 16, v103
    v_and_b32 v63, s47, v103
    v_add_f32 v48, v48, v56
    v_add_f32 v49, v49, v57
    v_add_f32 v50, v50, v58
    v_add_f32 v51, v51, v59
    v_add_f32 v52, v52, v60
    v_add_f32 v53, v53, v61
    v_add_f32 v54, v54, v62
    v_add_f32 v55, v55, v63
    s_waitcnt vmcnt(5)
    v_lshlrev_b32 v56, 16, v104
    v_and_b32 v57, s47, v104
    v_lshlrev_b32 v58, 16, v105
    v_and_b32 v59, s47, v105
    v_lshlrev_b32 v60, 16, v106
    v_and_b32 v61, s47, v106
    v_lshlrev_b32 v62, 16, v107
    v_and_b32 v63, s47, v107
    v_add_f32 v48, v48, v56
    v_add_f32 v49, v49, v57
    v_add_f32 v50, v50, v58
    v_add_f32 v51, v51, v59
    v_add_f32 v52, v52, v60
    v_add_f32 v53, v53, v61
    v_add_f32 v54, v54, v62
    v_add_f32 v55, v55, v63
    s_waitcnt vmcnt(4)
    v_lshlrev_b32 v56, 16, v108
    v_and_b32 v57, s47, v108
    v_lshlrev_b32 v58, 16, v109
    v_and_b32 v59, s47, v109
    v_lshlrev_b32 v60, 16, v110
    v_and_b32 v61, s47, v110
    v_lshlrev_b32 v62, 16, v111
    v_and_b32 v63, s47, v111
    v_add_f32 v48, v48, v56
    v_add_f32 v49, v49, v57
    v_add_f32 v50, v50, v58
    v_add_f32 v51, v51, v59
    v_add_f32 v52, v52, v60
    v_add_f32 v53, v53, v61
    v_add_f32 v54, v54, v62
    v_add_f32 v55, v55, v63
    s_waitcnt vmcnt(3)
    v_lshlrev_b32 v56, 16, v112
    v_and_b32 v57, s47, v112
    v_lshlrev_b32 v58, 16, v113
    v_and_b32 v59, s47, v113
    v_lshlrev_b32 v60, 16, v114
    v_and_b32 v61, s47, v114
    v_lshlrev_b32 v62, 16, v115
    v_and_b32 v63, s47, v115
    v_add_f32 v48, v48, v56
    v_add_f32 v49, v49, v57
    v_add_f32 v50, v50, v58
    v_add_f32 v51, v51, v59
    v_add_f32 v52, v52, v60
    v_add_f32 v53, v53, v61
    v_add_f32 v54, v54, v62
    v_add_f32 v55, v55, v63
    s_waitcnt vmcnt(2)
    v_lshlrev_b32 v56, 16, v116
    v_and_b32 v57, s47, v116
    v_lshlrev_b32 v58, 16, v117
    v_and_b32 v59, s47, v117
    v_lshlrev_b32 v60, 16, v118
    v_and_b32 v61, s47, v118
    v_lshlrev_b32 v62, 16, v119
    v_and_b32 v63, s47, v119
    v_add_f32 v48, v48, v56
    v_add_f32 v49, v49, v57
    v_add_f32 v50, v50, v58
    v_add_f32 v51, v51, v59
    v_add_f32 v52, v52, v60
    v_add_f32 v53, v53, v61
    v_add_f32 v54, v54, v62
    v_add_f32 v55, v55, v63
    s_waitcnt vmcnt(1)
    v_lshlrev_b32 v56, 16, v120
    v_and_b32 v57, s47, v120
    v_lshlrev_b32 v58, 16, v121
    v_and_b32 v59, s47, v121
    v_lshlrev_b32 v60, 16, v122
    v_and_b32 v61, s47, v122
    v_lshlrev_b32 v62, 16, v123
    v_and_b32 v63, s47, v123
    v_add_f32 v48, v48, v56
    v_add_f32 v49, v49, v57
    v_add_f32 v50, v50, v58
    v_add_f32 v51, v51, v59
    v_add_f32 v52, v52, v60
    v_add_f32 v53, v53, v61
    v_add_f32 v54, v54, v62
    v_add_f32 v55, v55, v63
    s_waitcnt vmcnt(0)
    v_lshlrev_b32 v56, 16, v124
    v_and_b32 v57, s47, v124
    v_lshlrev_b32 v58, 16, v125
    v_and_b32 v59, s47, v125
    v_lshlrev_b32 v60, 16, v126
    v_and_b32 v61, s47, v126
    v_lshlrev_b32 v62, 16, v127
    v_and_b32 v63, s47, v127
    v_add_f32 v48, v48, v56
    v_add_f32 v49, v49, v57
    v_add_f32 v50, v50, v58
    v_add_f32 v51, v51, v59
    v_add_f32 v52, v52, v60
    v_add_f32 v53, v53, v61
    v_add_f32 v54, v54, v62
    v_add_f32 v55, v55, v63
    s_nop 0
    v_add_f32_dpp v48, v48, v48 row_ror:8 row_mask:0xf bank_mask:0xf
    v_add_f32_dpp v49, v49, v49 row_ror:8 row_mask:0xf bank_mask:0xf
    v_add_f32_dpp v50, v50, v50 row_ror:8 row_mask:0xf bank_mask:0xf
    v_add_f32_dpp v51, v51, v51 row_ror:8 row_mask:0xf bank_mask:0xf
    v_add_f32_dpp v52, v52, v52 row_ror:8 row_mask:0xf bank_mask:0xf
    v_add_f32_dpp v53, v53, v53 row_ror:8 row_mask:0xf bank_mask:0xf
    v_add_f32_dpp v54, v54, v54 row_ror:8 row_mask:0xf bank_mask:0xf
    v_add_f32_dpp v55, v55, v55 row_ror:8 row_mask:0xf bank_mask:0xf
    v_mov_b32 v56, v48
    v_mov_b32 v57, v49
    v_mov_b32 v58, v50
    v_mov_b32 v59, v51
    v_mov_b32 v60, v52
    v_mov_b32 v61, v53
    v_mov_b32 v62, v54
    v_mov_b32 v63, v55
    s_nop 1
    v_permlane16_swap_b32 v48, v56
    v_permlane16_swap_b32 v49, v57
    v_permlane16_swap_b32 v50, v58
    v_permlane16_swap_b32 v51, v59
    v_permlane16_swap_b32 v52, v60
    v_permlane16_swap_b32 v53, v61
    v_permlane16_swap_b32 v54, v62
    v_permlane16_swap_b32 v55, v63
    v_add_f32 v48, v48, v56
    v_add_f32 v49, v49, v57
    v_add_f32 v50, v50, v58
    v_add_f32 v51, v51, v59
    v_add_f32 v52, v52, v60
    v_add_f32 v53, v53, v61
    v_add_f32 v54, v54, v62
    v_add_f32 v55, v55, v63
    v_mov_b32 v56, v48
    v_mov_b32 v57, v49
    v_mov_b32 v58, v50
    v_mov_b32 v59, v51
    v_mov_b32 v60, v52
    v_mov_b32 v61, v53
    v_mov_b32 v62, v54
    v_mov_b32 v63, v55
    s_nop 1
    v_permlane32_swap_b32 v48, v56
    v_permlane32_swap_b32 v49, v57
    v_permlane32_swap_b32 v50, v58
    v_permlane32_swap_b32 v51, v59
    v_permlane32_swap_b32 v52, v60
    v_permlane32_swap_b32 v53, v61
    v_permlane32_swap_b32 v54, v62
    v_permlane32_swap_b32 v55, v63
    v_add_f32 v48, v48, v56
    v_add_f32 v49, v49, v57
    v_add_f32 v50, v50, v58
    v_add_f32 v51, v51, v59
    v_add_f32 v52, v52, v60
    v_add_f32 v53, v53, v61
    v_add_f32 v54, v54, v62
    v_add_f32 v55, v55, v63
    s_lshl_b32 s34, s27, 8
    s_add_u32 s34, s34, 148608
    v_lshl_add_u32 v13, v13, 5, s34
    ds_write_b128 v13, v[48:51]
    ds_write_b128 v13, v[52:55] offset:16
L_k2_xb:
    s_add_u32 s84, s16, 0x02800000
    s_addc_u32 s85, s17, 0
    s_mov_b32 s86, 0x00400000
    s_mov_b32 s87, 0x00020000
    v_mov_b32 v64, -1
    v_mov_b32 v65, -1
    v_mov_b32 v66, -1
    v_mov_b32 v67, -1
    v_lshlrev_b32 v68, 4, v14
    s_mul_i32 s43, s2, 16384
    s_lshl_b32 s42, s27, 12
    s_add_u32 s43, s43, s42
    buffer_store_dwordx4 v[64:67], v68, s[84:87], s43 offen offset:0 sc1
    buffer_store_dwordx4 v[64:67], v68, s[84:87], s43 offen offset:1024 sc1
    buffer_store_dwordx4 v[64:67], v68, s[84:87], s43 offen offset:2048 sc1
    buffer_store_dwordx4 v[64:67], v68, s[84:87], s43 offen offset:3072 sc1
    v_lshrrev_b32 v248, 2, v10
    v_mul_u32_u24 v248, 16672, v248
    v_lshl_add_u32 v248, v153, 4, v248
    v_lshl_add_u32 v248, v11, 6, v248
    s_lshl_b32 s36, s30, 9
    v_add_u32 v248, s36, v248
    s_lshl_b32 s37, s3, 14
    s_lshl_b32 s36, s30, 11
    s_add_u32 s36, s36, s37
    v_lshl_add_u32 v249, v14, 4, s36
    s_mov_b32 vcc_lo, 0x33333333
    s_mov_b32 vcc_hi, 0x33333333
    s_add_u32 s40, s16, 0x00c00000
    s_addc_u32 s41, s17, 0
    s_mov_b32 s42, 0x00400000
    s_mov_b32 s43, 0x00020000
L_k2_join:
    s_waitcnt lgkmcnt(0)
    s_barrier
    ds_read_b64_tr_b16 v[72:73], v248 offset:0
    ds_read_b64_tr_b16 v[74:75], v248 offset:8
    ds_read_b64_tr_b16 v[76:77], v248 offset:256
    ds_read_b64_tr_b16 v[78:79], v248 offset:264
    s_waitcnt lgkmcnt(3)
    v_lshlrev_b32 v26, 16, v72
    v_and_b32 v27, s47, v72
    v_pk_add_f32 v[26:27], v[26:27], v[232:233]
    v_cvt_pk_bf16_f32 v80, v26, v27
    v_lshlrev_b32 v26, 16, v73
    v_and_b32 v27, s47, v73
    v_pk_add_f32 v[26:27], v[26:27], v[234:235]
    v_cvt_pk_bf16_f32 v81, v26, v27
    s_waitcnt lgkmcnt(2)
    v_lshlrev_b32 v26, 16, v74
    v_and_b32 v27, s47, v74
    v_pk_add_f32 v[26:27], v[26:27], v[236:237]
    v_cvt_pk_bf16_f32 v82, v26, v27
    v_lshlrev_b32 v26, 16, v75
    v_and_b32 v27, s47, v75
    v_pk_add_f32 v[26:27], v[26:27], v[238:239]
    v_cvt_pk_bf16_f32 v83, v26, v27
    v_mov_b32_dpp v88, v80 quad_perm:[0,2,0,2] row_mask:0xf bank_mask:0xf
    v_mov_b32_dpp v89, v81 quad_perm:[0,2,0,2] row_mask:0xf bank_mask:0xf
    v_mov_b32_dpp v90, v80 quad_perm:[1,3,1,3] row_mask:0xf bank_mask:0xf
    v_mov_b32_dpp v91, v81 quad_perm:[1,3,1,3] row_mask:0xf bank_mask:0xf
    v_cndmask_b32_dpp v112, v82, v88, vcc quad_perm:[0,2,0,2] row_mask:0xf bank_mask:0xf
    v_cndmask_b32_dpp v113, v83, v89, vcc quad_perm:[0,2,0,2] row_mask:0xf bank_mask:0xf
    v_cndmask_b32_dpp v114, v82, v90, vcc quad_perm:[1,3,1,3] row_mask:0xf bank_mask:0xf
    v_cndmask_b32_dpp v115, v83, v91, vcc quad_perm:[1,3,1,3] row_mask:0xf bank_mask:0xf
    buffer_store_dwordx4 v[112:115], v249, s[40:43], 0 offen offset:0 sc1
    s_waitcnt lgkmcnt(1)
    v_lshlrev_b32 v26, 16, v76
    v_and_b32 v27, s47, v76
    v_pk_add_f32 v[26:27], v[26:27], v[240:241]
    v_cvt_pk_bf16_f32 v84, v26, v27
    v_lshlrev_b32 v26, 16, v77
    v_and_b32 v27, s47, v77
    v_pk_add_f32 v[26:27], v[26:27], v[242:243]
    v_cvt_pk_bf16_f32 v85, v26, v27
    s_waitcnt lgkmcnt(0)
    v_lshlrev_b32 v26, 16, v78
    v_and_b32 v27, s47, v78
    v_pk_add_f32 v[26:27], v[26:27], v[244:245]
    v_cvt_pk_bf16_f32 v86, v26, v27
    v_lshlrev_b32 v26, 16, v79
    v_and_b32 v27, s47, v79
    v_pk_add_f32 v[26:27], v[26:27], v[246:247]
    v_cvt_pk_bf16_f32 v87, v26, v27
    v_mov_b32_dpp v88, v84 quad_perm:[0,2,0,2] row_mask:0xf bank_mask:0xf
    v_mov_b32_dpp v89, v85 quad_perm:[0,2,0,2] row_mask:0xf bank_mask:0xf
    v_mov_b32_dpp v90, v84 quad_perm:[1,3,1,3] row_mask:0xf bank_mask:0xf
    v_mov_b32_dpp v91, v85 quad_perm:[1,3,1,3] row_mask:0xf bank_mask:0xf
    v_cndmask_b32_dpp v116, v86, v88, vcc quad_perm:[0,2,0,2] row_mask:0xf bank_mask:0xf
    v_cndmask_b32_dpp v117, v87, v89, vcc quad_perm:[0,2,0,2] row_mask:0xf bank_mask:0xf
    v_cndmask_b32_dpp v118, v86, v90, vcc quad_perm:[1,3,1,3] row_mask:0xf bank_mask:0xf
    v_cndmask_b32_dpp v119, v87, v91, vcc quad_perm:[1,3,1,3] row_mask:0xf bank_mask:0xf
    buffer_store_dwordx4 v[116:119], v249, s[40:43], 0 offen offset:1024 sc1
    s_cmp_eq_u32 s30, 4
    s_cbranch_scc0 L_k2_nocs
    s_cmp_eq_u32 s64, 0
    s_cbranch_scc1 L_k2_nocs
    v_lshlrev_b32 v29, 2, v14
    v_add_u32 v28, 148608, v29
    ds_read_b32 v48, v28
    ds_read_b32 v49, v28 offset:256
    ds_read_b32 v50, v28 offset:512
    ds_read_b32 v51, v28 offset:768
    s_add_u32 s48, s16, 0x01700000
    s_addc_u32 s49, s17, 0
    s_mov_b32 s50, 0x0000e000
    s_mov_b32 s51, 0x00020000
    s_mul_i32 s34, s32, 28672
    s_lshl_b32 s35, s33, 8
    s_add_u32 s34, s34, s35
    s_waitcnt lgkmcnt(0)
    v_pk_add_f32 v[48:49], v[48:49], v[50:51]
    v_add_f32 v48, v48, v49
    buffer_store_dword v48, v29, s[48:51], s34 offen sc1
L_k2_nocs:
    s_mov_b32 s72, s13
    s_mov_b32 s73, s3
    s_load_dwordx4 s[4:7], s[0:1], 64
    s_load_dwordx2 s[8:9], s[0:1], 104
    s_load_dwordx2 s[10:11], s[0:1], 80
    s_load_dwordx2 s[74:75], s[0:1], 88
    v_lshrrev_b32 v1, 6, v0
    v_and_b32 v14, 63, v0
    v_readfirstlane_b32 s30, v1
    s_and_b32 s31, s2, 7
    s_lshr_b32 s32, s2, 3
    s_and_b32 s33, s32, 7
    s_lshr_b32 s32, s32, 3
    s_lshl_b32 s31, s31, 2
    s_add_u32 s34, s31, s32
    s_mov_b32 s47, 0xffff0000
    s_lshr_b32 s38, s30, 1
    s_and_b32 s39, s30, 1
    v_lshrrev_b32 v15, 4, v14
    v_and_b32 v17, 15, v14
    s_lshl_b32 s35, s30, 14
    s_lshl_b32 s36, s33, 11
    s_add_u32 s35, s35, s36
    v_lshl_add_u32 v2, v14, 4, s35
    s_and_b32 s35, s38, 1
    s_lshl_b32 s35, s35, 3
    v_lshl_add_u32 v16, v15, 1, s35
    v_xor_b32 v16, v16, v17
    v_mul_u32_u24 v3, 7168, v15
    v_lshl_add_u32 v3, v16, 4, v3
    s_mul_i32 s35, s34, 224
    s_and_b32 s36, s35, 63
    s_sub_u32 s35, s35, s36
    s_lshr_b32 s37, s36, 5
    s_mul_i32 s36, s30, 28672
    s_add_u32 s35, s35, s36
    v_add_u32 v3, s35, v3
    s_mul_i32 s40, s30, 2112
    s_lshl_b32 s41, s30, 10
    s_add_u32 s41, s41, 16896
    s_add_u32 s42, s41, 8208
    s_mul_i32 s43, s31, 131072
    s_mul_i32 s44, s31, 229376
    v_mul_u32_u24 v4, 4224, v15
    v_lshl_add_u32 v4, v17, 3, v4
    s_lshl_b32 s35, s38, 9
    v_add_u32 v4, s35, v4
    v_lshrrev_b32 v18, 2, v17
    v_lshl_add_u32 v21, v15, 3, v18
    v_lshlrev_b32 v21, 8, v21
    v_add_u32 v21, 16896, v21
    v_and_b32 v20, 1, v15
    v_lshl_add_u32 v20, v20, 2, v18
    v_and_b32 v24, 3, v17
    v_lshl_add_u32 v22, v24, 3, v21
    s_lshl_b32 s35, s39, 2
    s_add_u32 s35, s35, s37
    s_add_u32 s36, s35, 0
    v_xor_b32 v23, s36, v20
    v_lshl_add_u32 v6, v23, 5, v22
    s_add_u32 s36, s35, 1
    v_xor_b32 v23, s36, v20
    v_lshl_add_u32 v7, v23, 5, v22
    s_add_u32 s36, s35, 2
    v_xor_b32 v23, s36, v20
    v_lshl_add_u32 v8, v23, 5, v22
    s_add_u32 s36, s37, 3
    v_xor_b32 v23, s36, v20
    v_lshl_add_u32 v23, v23, 5, v21
    v_and_b32 v25, 1, v24
    v_lshl_add_u32 v23, v25, 3, v23
    v_lshrrev_b32 v25, 1, v24
    v_mul_u32_u24 v25, 8208, v25
    s_lshl_b32 s36, s39, 4
    v_add3_u32 v9, v23, v25, s36
    s_waitcnt lgkmcnt(0)
    s_add_u32 s12, s8, 0x00c00000
    s_addc_u32 s13, s9, 0
    s_mov_b32 s14, 0x00400000
    s_mov_b32 s15, 0x00020000
    s_mov_b32 s16, s4
    s_mov_b32 s17, s5
    s_mov_b32 s18, 0x00700000
    s_mov_b32 s19, 0x00020000
    s_mov_b32 s20, s6
    s_mov_b32 s21, s7
    s_mov_b32 s22, 0x00700000
    s_mov_b32 s23, 0x00020000
    s_add_u32 s76, s8, 0x01750000
    s_addc_u32 s77, s9, 0
    s_mov_b32 s78, 0x00010000
    s_mov_b32 s79, 0x00020000
    v_mov_b32 v26, s72
    v_lshlrev_b32 v27, 7, v14
    s_lshl_b32 s46, s31, 10
    s_lshl_b32 s35, s73, 7
    s_waitcnt vmcnt(0)
    s_barrier
    s_cmp_eq_u32 s30, 0
    s_cbranch_scc0 L_g1_noarr
    s_mov_b64 exec, 1
    buffer_store_dword v26, v27, s[76:79], s35 offen sc1
    s_mov_b64 exec, -1
L_g1_noarr:
    s_add_u32 m0, s41, 0
    s_nop 0
    buffer_load_dwordx4 v3, s[16:19], s44 offen lds
    s_add_u32 m0, s42, 0
    s_nop 0
    buffer_load_dwordx4 v3, s[20:23], s44 offen lds
    s_add_u32 s44, s44, 229376
    s_add_u32 m0, s41, 33536
    s_nop 0
    buffer_load_dwordx4 v3, s[16:19], s44 offen lds
    s_add_u32 m0, s42, 33536
    s_nop 0
    buffer_load_dwordx4 v3, s[20:23], s44 offen lds
    s_add_u32 s44, s44, 229376
    s_add_u32 m0, s41, 67072
    s_nop 0
    buffer_load_dwordx4 v3, s[16:19], s44 offen lds
    s_add_u32 m0, s42, 67072
    s_nop 0
    buffer_load_dwordx4 v3, s[20:23], s44 offen lds
    s_add_u32 s44, s44, 229376
    s_add_u32 m0, s41, 100608
    s_nop 0
    buffer_load_dwordx4 v3, s[16:19], s44 offen lds
    s_add_u32 m0, s42, 100608
    s_nop 0
    buffer_load_dwordx4 v3, s[20:23], s44 offen lds
    s_add_u32 s44, s44, 229376
    v_add_u32 v5, 67072, v4
    v_add_u32 v10, 67072, v6
    v_add_u32 v11, 67072, v7
    v_add_u32 v12, 67072, v8
    v_add_u32 v13, 67072, v9
    s_add_u32 s24, s8, 0x01700000
    s_addc_u32 s25, s9, 0
    s_mov_b32 s26, 0x0000e000
    s_mov_b32 s27, 0x00020000
    s_mov_b32 s64, s10
    s_mov_b32 s65, s11
    s_mov_b32 s66, 0x00700000
    s_mov_b32 s67, 0x00020000
    s_add_u32 s56, s8, 0x01740000
    s_addc_u32 s57, s9, 0
    s_mov_b32 s58, 0x00008000
    s_mov_b32 s59, 0x00020000
    v_lshrrev_b32 v18, 2, v14
    v_lshlrev_b32 v18, 14, v18
    v_lshl_add_u32 v18, v24, 4, v18
    s_lshl_b32 s48, s33, 5
    s_add_u32 s48, s48, s34
    s_lshl_b32 s35, s48, 6
    s_and_b32 s36, s30, 3
    s_lshl_b32 s36, s36, 20
    s_add_u32 s49, s35, s36
    v_and_b32 v16, 255, v0
    v_cmp_le_u32 vcc, 112, v16
    v_mov_b32 v19, 3472
    s_mul_i32 s35, s34, 112
    v_cndmask_b32 v19, 0, v19, vcc
    v_add3_u32 v19, v19, v16, s35
    v_lshlrev_b32 v19, 2, v19
    s_mov_b32 s50, 28672
    s_lshl_b32 s54, s33, 12
    s_lshl_b32 s35, s38, 10
    s_add_u32 s54, s54, s35
    v_lshl_add_u32 v132, v17, 4, s54
    v_and_b32 v133, 2, v15
    v_lshl_add_u32 v133, v133, 7, v132
    s_lshl_b32 s35, s2, 3
    s_add_u32 s35, s35, s30
    s_mul_i32 s35, s35, 3584
    v_min_u32 v31, 27, v14
    v_lshl_add_u32 v31, v31, 7, s35
    s_add_u32 s55, s38, 1
    s_lshr_b32 s28, s34, 4
    s_lshl1_add_u32 s28, s33, s28
    s_lshl_b32 s28, s48, 7
    s_add_u32 s28, s28, 32768
    v_lshrrev_b32 v137, 1, v15
    v_and_b32 v135, 1, v15
    v_lshl_add_u32 v134, v135, 8, v132
    v_lshl_add_u32 v134, v137, 15, v134
    s_mul_i32 s35, s34, 14
    s_lshl_b32 s36, s39, 3
    s_add_u32 s36, s36, s35
    s_lshl_b32 s36, s36, 15
    v_add_u32 v134, s36, v134
    s_add_u32 s35, s35, 6
    s_add_u32 s35, s35, s39
    s_lshl_b32 s35, s35, 15
    s_lshl_b32 s36, s39, 5
    s_add_u32 s36, s36, 134848
    v_lshl_add_u32 v21, v135, 4, s36
    v_lshl_add_u32 v135, v135, 9, v132
    v_lshl_add_u32 v135, v137, 8, v135
    v_add_u32 v135, s35, v135
    s_lshl_b32 s35, s39, 8
    s_add_u32 s35, s35, 134656
    v_lshl_add_u32 v20, v15, 4, s35
    s_cmp_ge_u32 s30, 4
    s_cbranch_scc0 L_g1_np
    s_setprio 1
L_g1_np:
    s_cmp_eq_u32 s30, 0
    s_cbranch_scc0 L_g1_go
    s_mov_b64 exec, 1
    s_mov_b32 exec_lo, -1
    s_mov_b32 s53, 0
L_g1_wait1:
    buffer_load_dword v28, v27, s[76:79], s46 offen sc1
    s_add_u32 s53, s53, 1
    s_waitcnt vmcnt(0)
    v_cmp_ne_u32 vcc, s72, v28
    s_cmp_ge_u32 s53, 0x80000
    s_cbranch_vccz L_g1_seen1
    s_sleep 1
    s_cbranch_scc0 L_g1_wait1
L_g1_seen1:
    s_mov_b64 exec, -1
L_g1_go:
    s_barrier
    s_add_u32 m0, s40, 0
    s_nop 0
    buffer_load_dwordx4 v2, s[12:15], s43 offen sc1 lds
    buffer_load_dwordx4 v2, s[12:15], s43 offen offset:1024 sc1 lds
    s_add_u32 s43, s43, 131072
    s_add_u32 m0, s40, 33536
    s_nop 0
    buffer_load_dwordx4 v2, s[12:15], s43 offen sc1 lds
    buffer_load_dwordx4 v2, s[12:15], s43 offen offset:1024 sc1 lds
    s_add_u32 s43, s43, 131072
    s_waitcnt vmcnt(2)
    s_barrier
    ds_read_b64 v[32:33], v4 offset:0
    ds_read_b64 v[34:35], v4 offset:2112
    ds_read_b64 v[36:37], v4 offset:128
    ds_read_b64 v[38:39], v4 offset:2240
    ds_read_b64 v[40:41], v4 offset:256
    ds_read_b64 v[42:43], v4 offset:2368
    ds_read_b64 v[44:45], v4 offset:384
    ds_read_b64 v[46:47], v4 offset:2496
    ds_read_b64_tr_b16 v[48:49], v6 offset:0
    ds_read_b64_tr_b16 v[50:51], v6 offset:1024
    ds_read_b64_tr_b16 v[52:53], v7 offset:0
    ds_read_b64_tr_b16 v[54:55], v7 offset:1024
    ds_read_b64_tr_b16 v[56:57], v8 offset:0
    ds_read_b64_tr_b16 v[58:59], v8 offset:1024
    ds_read_b64_tr_b16 v[60:61], v6 offset:8208
    ds_read_b64_tr_b16 v[62:63], v6 offset:9232
    ds_read_b64_tr_b16 v[64:65], v7 offset:8208
    ds_read_b64_tr_b16 v[66:67], v7 offset:9232
    ds_read_b64_tr_b16 v[68:69], v8 offset:8208
    ds_read_b64_tr_b16 v[70:71], v8 offset:9232
    ds_read_b64_tr_b16 v[72:73], v9 offset:0
    ds_read_b64_tr_b16 v[74:75], v9 offset:1024
    s_mov_b32 s53, 0
    s_add_u32 s35, s46, 4096
    s_and_b32 s35, s35, 0x7fff
    s_cmp_eq_u32 s30, 0
    s_cbranch_scc0 L_g1_nc8
    s_mov_b32 exec_hi, 0
    buffer_load_dword v28, v27, s[76:79], s35 offen sc1
    s_mov_b32 exec_hi, -1
L_g1_nc8:
    s_add_u32 m0, s40, 67072
    s_nop 0
    buffer_load_dwordx4 v2, s[12:15], s43 offen sc1 lds
    buffer_load_dwordx4 v2, s[12:15], s43 offen offset:1024 sc1 lds
    s_add_u32 s43, s43, 131072
    s_add_u32 m0, s40, 100608
    s_nop 0
    buffer_load_dwordx4 v2, s[12:15], s43 offen sc1 lds
    buffer_load_dwordx4 v2, s[12:15], s43 offen offset:1024 sc1 lds
    s_add_u32 s43, s43, 131072
    s_cmp_eq_u32 s43, 4194304
    s_cselect_b32 s43, 0, s43
    s_cselect_b32 s44, 0, s44
    s_waitcnt lgkmcnt(12)
    v_mfma_f32_16x16x32_bf16 v[144:147], v[48:51], v[32:35], 0
    v_mfma_f32_16x16x32_bf16 v[148:151], v[48:51], v[36:39], 0
    v_mfma_f32_16x16x32_bf16 v[152:155], v[48:51], v[40:43], 0
    v_mfma_f32_16x16x32_bf16 v[156:159], v[48:51], v[44:47], 0
    s_waitcnt lgkmcnt(10)
    v_mfma_f32_16x16x32_bf16 v[172:175], v[52:55], v[44:47], 0
    v_mfma_f32_16x16x32_bf16 v[168:171], v[52:55], v[40:43], 0
    v_mfma_f32_16x16x32_bf16 v[164:167], v[52:55], v[36:39], 0
    v_mfma_f32_16x16x32_bf16 v[160:163], v[52:55], v[32:35], 0
    s_waitcnt lgkmcnt(8)
    v_mfma_f32_16x16x32_bf16 v[176:179], v[56:59], v[32:35], 0
    v_mfma_f32_16x16x32_bf16 v[180:183], v[56:59], v[36:39], 0
    v_mfma_f32_16x16x32_bf16 v[184:187], v[56:59], v[40:43], 0
    v_mfma_f32_16x16x32_bf16 v[188:191], v[56:59], v[44:47], 0
    s_waitcnt lgkmcnt(6)
    v_mfma_f32_16x16x32_bf16 v[204:207], v[60:63], v[44:47], 0
    v_mfma_f32_16x16x32_bf16 v[200:203], v[60:63], v[40:43], 0
    v_mfma_f32_16x16x32_bf16 v[196:199], v[60:63], v[36:39], 0
    v_mfma_f32_16x16x32_bf16 v[192:195], v[60:63], v[32:35], 0
    s_waitcnt vmcnt(4) lgkmcnt(0)
    s_cmp_eq_u32 s30, 0
    s_cbranch_scc0 L_g1_all
    s_mov_b32 exec_hi, 0
L_g1_wait8:
    v_cmp_ne_u32 vcc, s72, v28
    s_add_u32 s53, s53, 1
    s_cbranch_vccz L_g1_seen8
    s_cmp_ge_u32 s53, 0x80000
    s_cbranch_scc1 L_g1_seen8
    s_sleep 1
    buffer_load_dword v28, v27, s[76:79], s35 offen sc1
    s_waitcnt vmcnt(0)
    s_branch L_g1_wait8
L_g1_seen8:
    s_mov_b64 exec, -1
L_g1_all:
    s_barrier
    v_mfma_f32_16x16x32_bf16 v[208:211], v[64:67], v[32:35], 0
    ds_read_b64 v[76:77], v4 offset:33536
    ds_read_b64 v[78:79], v4 offset:35648
    v_mfma_f32_16x16x32_bf16 v[212:215], v[64:67], v[36:39], 0
    ds_read_b64 v[80:81], v4 offset:33664
    ds_read_b64 v[82:83], v4 offset:35776
    ds_read_b64 v[84:85], v4 offset:33792
    v_mfma_f32_16x16x32_bf16 v[216:219], v[64:67], v[40:43], 0
    ds_read_b64 v[86:87], v4 offset:35904
    ds_read_b64 v[88:89], v4 offset:33920
    v_mfma_f32_16x16x32_bf16 v[220:223], v[64:67], v[44:47], 0
    ds_read_b64 v[90:91], v4 offset:36032
    ds_read_b64_tr_b16 v[92:93], v6 offset:33536
    ds_read_b64_tr_b16 v[94:95], v6 offset:34560
    v_mfma_f32_16x16x32_bf16 v[236:239], v[68:71], v[44:47], 0
    ds_read_b64_tr_b16 v[96:97], v7 offset:33536
    s_add_u32 m0, s40, 0
    v_mfma_f32_16x16x32_bf16 v[232:235], v[68:71], v[40:43], 0
    ds_read_b64_tr_b16 v[98:99], v7 offset:34560
    buffer_load_dwordx4 v2, s[12:15], s43 offen sc1 lds
    ds_read_b64_tr_b16 v[100:101], v8 offset:33536
    v_mfma_f32_16x16x32_bf16 v[228:231], v[68:71], v[36:39], 0
    buffer_load_dwordx4 v2, s[12:15], s43 offen offset:1024 sc1 lds
    ds_read_b64_tr_b16 v[102:103], v8 offset:34560
    s_add_u32 m0, s41, 0
    v_mfma_f32_16x16x32_bf16 v[224:227], v[68:71], v[32:35], 0
    ds_read_b64_tr_b16 v[104:105], v6 offset:41744
    buffer_load_dwordx4 v3, s[16:19], s44 offen lds
    v_mfma_f32_16x16x32_bf16 v[240:243], v[72:75], v[32:35], 0
    ds_read_b64_tr_b16 v[106:107], v6 offset:42768
    s_add_u32 m0, s42, 0
    ds_read_b64_tr_b16 v[108:109], v7 offset:41744
    v_mfma_f32_16x16x32_bf16 v[244:247], v[72:75], v[36:39], 0
    buffer_load_dwordx4 v3, s[20:23], s44 offen lds
    ds_read_b64_tr_b16 v[110:111], v7 offset:42768
    v_mfma_f32_16x16x32_bf16 v[248:251], v[72:75], v[40:43], 0
    s_add_u32 s43, s43, 131072
    ds_read_b64_tr_b16 v[112:113], v8 offset:41744
    s_add_u32 s44, s44, 229376
    v_mfma_f32_16x16x32_bf16 v[252:255], v[72:75], v[44:47], 0
    ds_read_b64_tr_b16 v[114:115], v8 offset:42768
    ds_read_b64_tr_b16 v[116:117], v9 offset:33536
    ds_read_b64_tr_b16 v[118:119], v9 offset:34560
    s_mov_b32 s45, 0
    s_waitcnt vmcnt(6) lgkmcnt(0)
    s_and_b32 s52, s30, 3
    s_lshl_b32 s52, s52, 13
    s_cmp_ge_u32 s30, 4
    s_cbranch_scc0 L_g1_nca
    buffer_load_dword v28, v27, s[76:79], s52 offen sc1
L_g1_nca:
    s_barrier
    s_branch L_g1_s1
L_g1_side:
    s_cmp_eq_u32 s45, 1
    s_cbranch_scc0 L_g1_side2
    s_waitcnt vmcnt(8) lgkmcnt(0)
    buffer_load_dwordx4 v[120:123], v18, s[12:15], s49 offen sc1
    s_add_u32 s49, s49, 262144
    buffer_load_dwordx4 v[124:127], v18, s[12:15], s49 offen sc1
    s_add_u32 s49, s49, 262144
    buffer_load_dword v128, v19, s[24:27], 0 offen sc1
    buffer_load_dword v129, v19, s[24:27], s50 offen sc1
    v_mov_b32 v138, 0
    v_mov_b32 v139, 0
    v_mov_b32 v142, 0
    v_mov_b32 v143, 0
    s_branch L_g1_bar2
L_g1_side2:
    s_sub_u32 s35, s45, 2
    s_cmp_lt_u32 s35, 2
    s_cbranch_scc0 L_g1_side4
    v_lshlrev_b32 v26, 16, v120
    v_and_b32 v27, s47, v120
    v_add_f32 v138, v138, v26
    v_fmac_f32 v139, v26, v26
    v_add_f32 v138, v138, v27
    v_fmac_f32 v139, v27, v27
    v_lshlrev_b32 v26, 16, v121
    v_and_b32 v27, s47, v121
    v_add_f32 v138, v138, v26
    v_fmac_f32 v139, v26, v26
    v_add_f32 v138, v138, v27
    v_fmac_f32 v139, v27, v27
    v_lshlrev_b32 v26, 16, v122
    v_and_b32 v27, s47, v122
    v_add_f32 v142, v142, v26
    v_fmac_f32 v143, v26, v26
    v_add_f32 v142, v142, v27
    v_fmac_f32 v143, v27, v27
    v_lshlrev_b32 v26, 16, v123
    v_and_b32 v27, s47, v123
    v_add_f32 v142, v142, v26
    v_fmac_f32 v143, v26, v26
    v_add_f32 v142, v142, v27
    v_fmac_f32 v143, v27, v27
    v_lshlrev_b32 v26, 16, v124
    v_and_b32 v27, s47, v124
    v_add_f32 v138, v138, v26
    v_fmac_f32 v139, v26, v26
    v_add_f32 v138, v138, v27
    v_fmac_f32 v139, v27, v27
    v_lshlrev_b32 v26, 16, v125
    v_and_b32 v27, s47, v125
    v_add_f32 v138, v138, v26
    v_fmac_f32 v139, v26, v26
    v_add_f32 v138, v138, v27
    v_fmac_f32 v139, v27, v27
    v_lshlrev_b32 v26, 16, v126
    v_and_b32 v27, s47, v126
    v_add_f32 v142, v142, v26
    v_fmac_f32 v143, v26, v26
    v_add_f32 v142, v142, v27
    v_fmac_f32 v143, v27, v27
    v_lshlrev_b32 v26, 16, v127
    v_and_b32 v27, s47, v127
    v_add_f32 v142, v142, v26
    v_fmac_f32 v143, v26, v26
    v_add_f32 v142, v142, v27
    v_fmac_f32 v143, v27, v27
    s_cmp_eq_u32 s45, 2
    s_cbranch_scc0 L_g1_nost
    s_waitcnt vmcnt(8) lgkmcnt(0)
    buffer_load_dwordx4 v[120:123], v18, s[12:15], s49 offen sc1
    s_add_u32 s49, s49, 262144
    buffer_load_dwordx4 v[124:127], v18, s[12:15], s49 offen sc1
    s_add_u32 s49, s49, 262144
    s_branch L_g1_bar2
L_g1_side4:
    s_cmp_eq_u32 s45, 4
    s_cbranch_scc0 L_g1_side5
    v_add_f32_dpp v138, v138, v138 row_ror:4 row_mask:0xf bank_mask:0xf
    v_add_f32_dpp v139, v139, v139 row_ror:4 row_mask:0xf bank_mask:0xf
    v_add_f32_dpp v142, v142, v142 row_ror:4 row_mask:0xf bank_mask:0xf
    v_add_f32_dpp v143, v143, v143 row_ror:4 row_mask:0xf bank_mask:0xf
    v_add_f32_dpp v138, v138, v138 row_ror:8 row_mask:0xf bank_mask:0xf
    v_add_f32_dpp v139, v139, v139 row_ror:8 row_mask:0xf bank_mask:0xf
    v_add_f32_dpp v142, v142, v142 row_ror:8 row_mask:0xf bank_mask:0xf
    v_add_f32_dpp v143, v143, v143 row_ror:8 row_mask:0xf bank_mask:0xf
    v_add_f32 v128, v128, v129
    v_lshlrev_b32 v28, 2, v16
    v_permlane16_swap_b32 v138, v142
    v_permlane16_swap_b32 v139, v143
    v_add_f32 v138, v138, v142
    v_add_f32 v139, v139, v143
    v_add_u32 v28, 134656, v28
    v_mov_b32 v142, v138
    v_mov_b32 v143, v139
    v_and_b32 v26, 1, v15
    v_lshl_add_u32 v26, v24, 1, v26
    v_permlane32_swap_b32 v138, v142
    v_permlane32_swap_b32 v139, v143
    v_add_f32 v138, v138, v142
    v_add_f32 v139, v139, v143
    s_lshl_b32 s35, s30, 3
    s_add_u32 s35, s35, 134112
    v_lshl_add_u32 v26, v26, 5, s35
    ds_write_b64 v26, v[138:139]
    ds_write_b32 v28, v128
    s_branch L_g1_nost
L_g1_side5:
L_g1_side6:
    s_cmp_eq_u32 s45, 0
    s_cbranch_scc0 L_g1_side7
    s_waitcnt vmcnt(8)
L_g1_waita:
    v_cmp_ne_u32 vcc, s72, v28
    s_add_u32 s53, s53, 1
    s_cbranch_vccz L_g1_nost
    s_cmp_ge_u32 s53, 0x80000
    s_cbranch_scc1 L_g1_nost
    s_sleep 1
    buffer_load_dword v28, v27, s[76:79], s52 offen sc1
    s_waitcnt vmcnt(0)
    s_branch L_g1_waita
L_g1_side7:
    s_lshl4_add_u32 s35, s45, s30
    s_cmp_eq_u32 s35, 87
    s_cbranch_scc0 L_g1_nost
    v_and_b32 v25, 31, v14
    v_lshlrev_b32 v28, 3, v25
    v_add_u32 v28, 134144, v28
    ds_read_b64 v[26:27], v28
    s_waitcnt lgkmcnt(0)
    v_add_f32_dpp v26, v26, v26 quad_perm:[1,0,3,2] row_mask:0xf bank_mask:0xf
    v_add_f32_dpp v27, v27, v27 quad_perm:[1,0,3,2] row_mask:0xf bank_mask:0xf
    s_nop 0
    v_add_f32_dpp v26, v26, v26 quad_perm:[2,3,0,1] row_mask:0xf bank_mask:0xf
    v_add_f32_dpp v27, v27, v27 quad_perm:[2,3,0,1] row_mask:0xf bank_mask:0xf
    v_mul_f32 v26, 0x3a800000, v26
    v_mul_f32 v27, 0x3a800000, v27
    v_fma_f32 v27, -v26, v26, v27
    v_max_f32 v27, 0, v27
    v_cvt_pk_bf16_f32 v26, v26, v27
    v_and_b32 v27, s47, v26
    v_lshlrev_b32 v26, 16, v26
    v_add_f32 v27, 0x3727c5ac, v27
    v_cvt_pk_bf16_f32 v27, v27, v27
    v_and_b32 v27, s47, v27
    v_sqrt_f32 v27, v27
    v_and_b32 v25, 28, v14
    v_cvt_pk_bf16_f32 v27, v27, v27
    v_and_b32 v27, s47, v27
    v_rcp_f32 v28, v27
    v_lshlrev_b32 v25, 2, v25
    v_mul_f32 v27, v27, v27
    v_mul_f32 v29, v28, v28
    v_mul_f32 v29, v29, v28
    v_mul_f32 v28, 0xc0135761, v28
    v_mul_f32 v29, 0xbdd2d3e8, v29
    s_lshl_b32 s35, s48, 7
    v_and_b32 v27, -2, v27
    v_and_b32 v28, -2, v28
    v_and_b32 v29, -2, v29
    buffer_store_dwordx4 v[26:29], v25, s[56:59], s35 offen sc1
    s_branch L_g1_nost
.p2align 6
L_g1_loop:
    v_mfma_f32_16x16x32_bf16 v[144:147], v[48:51], v[32:35], v[144:147]
    ds_read_b64 v[76:77], v4 offset:33536
    v_mfma_f32_16x16x32_bf16 v[148:151], v[48:51], v[36:39], v[148:151]
    ds_read_b64 v[78:79], v4 offset:35648
    v_mfma_f32_16x16x32_bf16 v[152:155], v[48:51], v[40:43], v[152:155]
    ds_read_b64 v[80:81], v4 offset:33664
    v_mfma_f32_16x16x32_bf16 v[156:159], v[48:51], v[44:47], v[156:159]
    ds_read_b64 v[82:83], v4 offset:35776
    v_mfma_f32_16x16x32_bf16 v[172:175], v[52:55], v[44:47], v[172:175]
    ds_read_b64 v[84:85], v4 offset:33792
    v_mfma_f32_16x16x32_bf16 v[168:171], v[52:55], v[40:43], v[168:171]
    ds_read_b64 v[86:87], v4 offset:35904
    v_mfma_f32_16x16x32_bf16 v[164:167], v[52:55], v[36:39], v[164:167]
    ds_read_b64 v[88:89], v4 offset:33920
    v_mfma_f32_16x16x32_bf16 v[160:163], v[52:55], v[32:35], v[160:163]
    ds_read_b64 v[90:91], v4 offset:36032
    v_mfma_f32_16x16x32_bf16 v[176:179], v[56:59], v[32:35], v[176:179]
    ds_read_b64_tr_b16 v[92:93], v6 offset:33536
    v_mfma_f32_16x16x32_bf16 v[180:183], v[56:59], v[36:39], v[180:183]
    ds_read_b64_tr_b16 v[94:95], v6 offset:34560
    v_mfma_f32_16x16x32_bf16 v[184:187], v[56:59], v[40:43], v[184:187]
    ds_read_b64_tr_b16 v[96:97], v7 offset:33536
    v_mfma_f32_16x16x32_bf16 v[188:191], v[56:59], v[44:47], v[188:191]
    ds_read_b64_tr_b16 v[98:99], v7 offset:34560
    v_mfma_f32_16x16x32_bf16 v[204:207], v[60:63], v[44:47], v[204:207]
    ds_read_b64_tr_b16 v[100:101], v8 offset:33536
    v_mfma_f32_16x16x32_bf16 v[200:203], v[60:63], v[40:43], v[200:203]
    s_add_u32 m0, s40, 0
    ds_read_b64_tr_b16 v[102:103], v8 offset:34560
    v_mfma_f32_16x16x32_bf16 v[196:199], v[60:63], v[36:39], v[196:199]
    buffer_load_dwordx4 v2, s[12:15], s43 offen sc1 lds
    v_mfma_f32_16x16x32_bf16 v[192:195], v[60:63], v[32:35], v[192:195]
    ds_read_b64_tr_b16 v[104:105], v6 offset:41744
    v_mfma_f32_16x16x32_bf16 v[208:211], v[64:67], v[32:35], v[208:211]
    ds_read_b64_tr_b16 v[106:107], v6 offset:42768
    v_mfma_f32_16x16x32_bf16 v[212:215], v[64:67], v[36:39], v[212:215]
    buffer_load_dwordx4 v2, s[12:15], s43 offen offset:1024 sc1 lds
    v_mfma_f32_16x16x32_bf16 v[216:219], v[64:67], v[40:43], v[216:219]
    s_add_u32 m0, s41, 0
    ds_read_b64_tr_b16 v[108:109], v7 offset:41744
    v_mfma_f32_16x16x32_bf16 v[220:223], v[64:67], v[44:47], v[220:223]
    ds_read_b64_tr_b16 v[110:111], v7 offset:42768
    v_mfma_f32_16x16x32_bf16 v[236:239], v[68:71], v[44:47], v[236:239]
    buffer_load_dwordx4 v3, s[16:19], s44 offen lds
    v_mfma_f32_16x16x32_bf16 v[232:235], v[68:71], v[40:43], v[232:235]
    s_add_u32 m0, s42, 0
    ds_read_b64_tr_b16 v[112:113], v8 offset:41744
    v_mfma_f32_16x16x32_bf16 v[228:231], v[68:71], v[36:39], v[228:231]
    ds_read_b64_tr_b16 v[114:115], v8 offset:42768
    v_mfma_f32_16x16x32_bf16 v[224:227], v[68:71], v[32:35], v[224:227]
    buffer_load_dwordx4 v3, s[20:23], s44 offen lds
    v_mfma_f32_16x16x32_bf16 v[240:243], v[72:75], v[32:35], v[240:243]
    ds_read_b64_tr_b16 v[116:117], v9 offset:33536
    v_mfma_f32_16x16x32_bf16 v[244:247], v[72:75], v[36:39], v[244:247]
    ds_read_b64_tr_b16 v[118:119], v9 offset:34560
    v_mfma_f32_16x16x32_bf16 v[248:251], v[72:75], v[40:43], v[248:251]
    s_add_u32 s43, s43, 131072
    s_add_u32 s44, s44, 229376
    v_mfma_f32_16x16x32_bf16 v[252:255], v[72:75], v[44:47], v[252:255]
    s_waitcnt vmcnt(8) lgkmcnt(0)
    s_barrier
L_g1_s1:
    v_mfma_f32_16x16x32_bf16 v[144:147], v[92:95], v[76:79], v[144:147]
    ds_read_b64 v[32:33], v5 offset:0
    v_mfma_f32_16x16x32_bf16 v[148:151], v[92:95], v[80:83], v[148:151]
    ds_read_b64 v[34:35], v5 offset:2112
    v_mfma_f32_16x16x32_bf16 v[152:155], v[92:95], v[84:87], v[152:155]
    ds_read_b64 v[36:37], v5 offset:128
    v_mfma_f32_16x16x32_bf16 v[156:159], v[92:95], v[88:91], v[156:159]
    ds_read_b64 v[38:39], v5 offset:2240
    v_mfma_f32_16x16x32_bf16 v[172:175], v[96:99], v[88:91], v[172:175]
    ds_read_b64 v[40:41], v5 offset:256
    v_mfma_f32_16x16x32_bf16 v[168:171], v[96:99], v[84:87], v[168:171]
    ds_read_b64 v[42:43], v5 offset:2368
    v_mfma_f32_16x16x32_bf16 v[164:167], v[96:99], v[80:83], v[164:167]
    ds_read_b64 v[44:45], v5 offset:384
    v_mfma_f32_16x16x32_bf16 v[160:163], v[96:99], v[76:79], v[160:163]
    ds_read_b64 v[46:47], v5 offset:2496
    v_mfma_f32_16x16x32_bf16 v[176:179], v[100:103], v[76:79], v[176:179]
    ds_read_b64_tr_b16 v[48:49], v10 offset:0
    v_mfma_f32_16x16x32_bf16 v[180:183], v[100:103], v[80:83], v[180:183]
    ds_read_b64_tr_b16 v[50:51], v10 offset:1024
    v_mfma_f32_16x16x32_bf16 v[184:187], v[100:103], v[84:87], v[184:187]
    ds_read_b64_tr_b16 v[52:53], v11 offset:0
    v_mfma_f32_16x16x32_bf16 v[188:191], v[100:103], v[88:91], v[188:191]
    ds_read_b64_tr_b16 v[54:55], v11 offset:1024
    v_mfma_f32_16x16x32_bf16 v[204:207], v[104:107], v[88:91], v[204:207]
    ds_read_b64_tr_b16 v[56:57], v12 offset:0
    v_mfma_f32_16x16x32_bf16 v[200:203], v[104:107], v[84:87], v[200:203]
    s_add_u32 m0, s40, 33536
    ds_read_b64_tr_b16 v[58:59], v12 offset:1024
    v_mfma_f32_16x16x32_bf16 v[196:199], v[104:107], v[80:83], v[196:199]
    buffer_load_dwordx4 v2, s[12:15], s43 offen sc1 lds
    v_mfma_f32_16x16x32_bf16 v[192:195], v[104:107], v[76:79], v[192:195]
    ds_read_b64_tr_b16 v[60:61], v10 offset:8208
    v_mfma_f32_16x16x32_bf16 v[208:211], v[108:111], v[76:79], v[208:211]
    ds_read_b64_tr_b16 v[62:63], v10 offset:9232
    v_mfma_f32_16x16x32_bf16 v[212:215], v[108:111], v[80:83], v[212:215]
    buffer_load_dwordx4 v2, s[12:15], s43 offen offset:1024 sc1 lds
    v_mfma_f32_16x16x32_bf16 v[216:219], v[108:111], v[84:87], v[216:219]
    s_add_u32 m0, s41, 33536
    ds_read_b64_tr_b16 v[64:65], v11 offset:8208
    v_mfma_f32_16x16x32_bf16 v[220:223], v[108:111], v[88:91], v[220:223]
    ds_read_b64_tr_b16 v[66:67], v11 offset:9232
    v_mfma_f32_16x16x32_bf16 v[236:239], v[112:115], v[88:91], v[236:239]
    buffer_load_dwordx4 v3, s[16:19], s44 offen lds
    v_mfma_f32_16x16x32_bf16 v[232:235], v[112:115], v[84:87], v[232:235]
    s_add_u32 m0, s42, 33536
    ds_read_b64_tr_b16 v[68:69], v12 offset:8208
    v_mfma_f32_16x16x32_bf16 v[228:231], v[112:115], v[80:83], v[228:231]
    ds_read_b64_tr_b16 v[70:71], v12 offset:9232
    v_mfma_f32_16x16x32_bf16 v[224:227], v[112:115], v[76:79], v[224:227]
    buffer_load_dwordx4 v3, s[20:23], s44 offen lds
    v_mfma_f32_16x16x32_bf16 v[240:243], v[116:119], v[76:79], v[240:243]
    ds_read_b64_tr_b16 v[72:73], v13 offset:0
    v_mfma_f32_16x16x32_bf16 v[244:247], v[116:119], v[80:83], v[244:247]
    ds_read_b64_tr_b16 v[74:75], v13 offset:1024
    v_mfma_f32_16x16x32_bf16 v[248:251], v[116:119], v[84:87], v[248:251]
    s_add_u32 s43, s43, 131072
    s_add_u32 s44, s44, 229376
    v_mfma_f32_16x16x32_bf16 v[252:255], v[116:119], v[88:91], v[252:255]
    s_waitcnt vmcnt(8) lgkmcnt(0)
    s_barrier
L_g1_s2:
    v_mfma_f32_16x16x32_bf16 v[144:147], v[48:51], v[32:35], v[144:147]
    ds_read_b64 v[76:77], v5 offset:33536
    v_mfma_f32_16x16x32_bf16 v[148:151], v[48:51], v[36:39], v[148:151]
    ds_read_b64 v[78:79], v5 offset:35648
    v_mfma_f32_16x16x32_bf16 v[152:155], v[48:51], v[40:43], v[152:155]
    ds_read_b64 v[80:81], v5 offset:33664
    v_mfma_f32_16x16x32_bf16 v[156:159], v[48:51], v[44:47], v[156:159]
    ds_read_b64 v[82:83], v5 offset:35776
    v_mfma_f32_16x16x32_bf16 v[172:175], v[52:55], v[44:47], v[172:175]
    ds_read_b64 v[84:85], v5 offset:33792
    v_mfma_f32_16x16x32_bf16 v[168:171], v[52:55], v[40:43], v[168:171]
    ds_read_b64 v[86:87], v5 offset:35904
    v_mfma_f32_16x16x32_bf16 v[164:167], v[52:55], v[36:39], v[164:167]
    ds_read_b64 v[88:89], v5 offset:33920
    v_mfma_f32_16x16x32_bf16 v[160:163], v[52:55], v[32:35], v[160:163]
    ds_read_b64 v[90:91], v5 offset:36032
    v_mfma_f32_16x16x32_bf16 v[176:179], v[56:59], v[32:35], v[176:179]
    ds_read_b64_tr_b16 v[92:93], v10 offset:33536
    v_mfma_f32_16x16x32_bf16 v[180:183], v[56:59], v[36:39], v[180:183]
    ds_read_b64_tr_b16 v[94:95], v10 offset:34560
    v_mfma_f32_16x16x32_bf16 v[184:187], v[56:59], v[40:43], v[184:187]
    ds_read_b64_tr_b16 v[96:97], v11 offset:33536
    v_mfma_f32_16x16x32_bf16 v[188:191], v[56:59], v[44:47], v[188:191]
    ds_read_b64_tr_b16 v[98:99], v11 offset:34560
    v_mfma_f32_16x16x32_bf16 v[204:207], v[60:63], v[44:47], v[204:207]
    ds_read_b64_tr_b16 v[100:101], v12 offset:33536
    v_mfma_f32_16x16x32_bf16 v[200:203], v[60:63], v[40:43], v[200:203]
    s_add_u32 m0, s40, 67072
    ds_read_b64_tr_b16 v[102:103], v12 offset:34560
    v_mfma_f32_16x16x32_bf16 v[196:199], v[60:63], v[36:39], v[196:199]
    buffer_load_dwordx4 v2, s[12:15], s43 offen sc1 lds
    v_mfma_f32_16x16x32_bf16 v[192:195], v[60:63], v[32:35], v[192:195]
    ds_read_b64_tr_b16 v[104:105], v10 offset:41744
    v_mfma_f32_16x16x32_bf16 v[208:211], v[64:67], v[32:35], v[208:211]
    ds_read_b64_tr_b16 v[106:107], v10 offset:42768
    v_mfma_f32_16x16x32_bf16 v[212:215], v[64:67], v[36:39], v[212:215]
    buffer_load_dwordx4 v2, s[12:15], s43 offen offset:1024 sc1 lds
    v_mfma_f32_16x16x32_bf16 v[216:219], v[64:67], v[40:43], v[216:219]
    s_add_u32 m0, s41, 67072
    ds_read_b64_tr_b16 v[108:109], v11 offset:41744
    v_mfma_f32_16x16x32_bf16 v[220:223], v[64:67], v[44:47], v[220:223]
    ds_read_b64_tr_b16 v[110:111], v11 offset:42768
    v_mfma_f32_16x16x32_bf16 v[236:239], v[68:71], v[44:47], v[236:239]
    buffer_load_dwordx4 v3, s[16:19], s44 offen lds
    v_mfma_f32_16x16x32_bf16 v[232:235], v[68:71], v[40:43], v[232:235]
    s_add_u32 m0, s42, 67072
    ds_read_b64_tr_b16 v[112:113], v12 offset:41744
    v_mfma_f32_16x16x32_bf16 v[228:231], v[68:71], v[36:39], v[228:231]
    ds_read_b64_tr_b16 v[114:115], v12 offset:42768
    v_mfma_f32_16x16x32_bf16 v[224:227], v[68:71], v[32:35], v[224:227]
    buffer_load_dwordx4 v3, s[20:23], s44 offen lds
    v_mfma_f32_16x16x32_bf16 v[240:243], v[72:75], v[32:35], v[240:243]
    ds_read_b64_tr_b16 v[116:117], v13 offset:33536
    v_mfma_f32_16x16x32_bf16 v[244:247], v[72:75], v[36:39], v[244:247]
    ds_read_b64_tr_b16 v[118:119], v13 offset:34560
    v_mfma_f32_16x16x32_bf16 v[248:251], v[72:75], v[40:43], v[248:251]
    s_add_u32 s43, s43, 131072
    s_add_u32 s44, s44, 229376
    v_mfma_f32_16x16x32_bf16 v[252:255], v[72:75], v[44:47], v[252:255]
    s_cmp_ge_u32 s30, 4
    s_cbranch_scc1 L_g1_side
L_g1_nost:
    s_waitcnt vmcnt(8) lgkmcnt(0)
L_g1_bar2:
    s_barrier
    v_mfma_f32_16x16x32_bf16 v[144:147], v[92:95], v[76:79], v[144:147]
    ds_read_b64 v[32:33], v4 offset:0
    v_mfma_f32_16x16x32_bf16 v[148:151], v[92:95], v[80:83], v[148:151]
    ds_read_b64 v[34:35], v4 offset:2112
    v_mfma_f32_16x16x32_bf16 v[152:155], v[92:95], v[84:87], v[152:155]
    ds_read_b64 v[36:37], v4 offset:128
    v_mfma_f32_16x16x32_bf16 v[156:159], v[92:95], v[88:91], v[156:159]
    ds_read_b64 v[38:39], v4 offset:2240
    v_mfma_f32_16x16x32_bf16 v[172:175], v[96:99], v[88:91], v[172:175]
    ds_read_b64 v[40:41], v4 offset:256
    v_mfma_f32_16x16x32_bf16 v[168:171], v[96:99], v[84:87], v[168:171]
    ds_read_b64 v[42:43], v4 offset:2368
    v_mfma_f32_16x16x32_bf16 v[164:167], v[96:99], v[80:83], v[164:167]
    ds_read_b64 v[44:45], v4 offset:384
    v_mfma_f32_16x16x32_bf16 v[160:163], v[96:99], v[76:79], v[160:163]
    ds_read_b64 v[46:47], v4 offset:2496
    v_mfma_f32_16x16x32_bf16 v[176:179], v[100:103], v[76:79], v[176:179]
    ds_read_b64_tr_b16 v[48:49], v6 offset:0
    v_mfma_f32_16x16x32_bf16 v[180:183], v[100:103], v[80:83], v[180:183]
    ds_read_b64_tr_b16 v[50:51], v6 offset:1024
    v_mfma_f32_16x16x32_bf16 v[184:187], v[100:103], v[84:87], v[184:187]
    ds_read_b64_tr_b16 v[52:53], v7 offset:0
    v_mfma_f32_16x16x32_bf16 v[188:191], v[100:103], v[88:91], v[188:191]
    ds_read_b64_tr_b16 v[54:55], v7 offset:1024
    v_mfma_f32_16x16x32_bf16 v[204:207], v[104:107], v[88:91], v[204:207]
    ds_read_b64_tr_b16 v[56:57], v8 offset:0
    v_mfma_f32_16x16x32_bf16 v[200:203], v[104:107], v[84:87], v[200:203]
    s_add_u32 m0, s40, 100608
    ds_read_b64_tr_b16 v[58:59], v8 offset:1024
    v_mfma_f32_16x16x32_bf16 v[196:199], v[104:107], v[80:83], v[196:199]
    buffer_load_dwordx4 v2, s[12:15], s43 offen sc1 lds
    v_mfma_f32_16x16x32_bf16 v[192:195], v[104:107], v[76:79], v[192:195]
    ds_read_b64_tr_b16 v[60:61], v6 offset:8208
    v_mfma_f32_16x16x32_bf16 v[208:211], v[108:111], v[76:79], v[208:211]
    ds_read_b64_tr_b16 v[62:63], v6 offset:9232
    v_mfma_f32_16x16x32_bf16 v[212:215], v[108:111], v[80:83], v[212:215]
    buffer_load_dwordx4 v2, s[12:15], s43 offen offset:1024 sc1 lds
    v_mfma_f32_16x16x32_bf16 v[216:219], v[108:111], v[84:87], v[216:219]
    s_add_u32 m0, s41, 100608
    ds_read_b64_tr_b16 v[64:65], v7 offset:8208
    v_mfma_f32_16x16x32_bf16 v[220:223], v[108:111], v[88:91], v[220:223]
    ds_read_b64_tr_b16 v[66:67], v7 offset:9232
    v_mfma_f32_16x16x32_bf16 v[236:239], v[112:115], v[88:91], v[236:239]
    buffer_load_dwordx4 v3, s[16:19], s44 offen lds
    v_mfma_f32_16x16x32_bf16 v[232:235], v[112:115], v[84:87], v[232:235]
    s_add_u32 m0, s42, 100608
    ds_read_b64_tr_b16 v[68:69], v8 offset:8208
    v_mfma_f32_16x16x32_bf16 v[228:231], v[112:115], v[80:83], v[228:231]
    ds_read_b64_tr_b16 v[70:71], v8 offset:9232
    v_mfma_f32_16x16x32_bf16 v[224:227], v[112:115], v[76:79], v[224:227]
    buffer_load_dwordx4 v3, s[20:23], s44 offen lds
    v_mfma_f32_16x16x32_bf16 v[240:243], v[116:119], v[76:79], v[240:243]
    ds_read_b64_tr_b16 v[72:73], v9 offset:0
    v_mfma_f32_16x16x32_bf16 v[244:247], v[116:119], v[80:83], v[244:247]
    ds_read_b64_tr_b16 v[74:75], v9 offset:1024
    v_mfma_f32_16x16x32_bf16 v[248:251], v[116:119], v[84:87], v[248:251]
    s_add_u32 s43, s43, 131072
    s_add_u32 s44, s44, 229376
    s_cmp_eq_u32 s43, 4194304
    s_cselect_b32 s43, 0, s43
    s_cselect_b32 s44, 0, s44
    v_mfma_f32_16x16x32_bf16 v[252:255], v[116:119], v[88:91], v[252:255]
    s_add_u32 s45, s45, 1
    s_cmp_lt_u32 s45, 7
    s_waitcnt vmcnt(8) lgkmcnt(0)
    s_barrier
    s_cbranch_scc1 L_g1_loop
    buffer_load_dword v30, v31, s[64:67], 0 offen
    v_mfma_f32_16x16x32_bf16 v[144:147], v[48:51], v[32:35], v[144:147]
    ds_read_b64 v[76:77], v4 offset:33536
    v_mfma_f32_16x16x32_bf16 v[148:151], v[48:51], v[36:39], v[148:151]
    ds_read_b64 v[78:79], v4 offset:35648
    v_mfma_f32_16x16x32_bf16 v[152:155], v[48:51], v[40:43], v[152:155]
    ds_read_b64 v[80:81], v4 offset:33664
    v_mfma_f32_16x16x32_bf16 v[156:159], v[48:51], v[44:47], v[156:159]
    ds_read_b64 v[82:83], v4 offset:35776
    v_mfma_f32_16x16x32_bf16 v[172:175], v[52:55], v[44:47], v[172:175]
    ds_read_b64 v[84:85], v4 offset:33792
    v_mfma_f32_16x16x32_bf16 v[168:171], v[52:55], v[40:43], v[168:171]
    ds_read_b64 v[86:87], v4 offset:35904
    v_mfma_f32_16x16x32_bf16 v[164:167], v[52:55], v[36:39], v[164:167]
    ds_read_b64 v[88:89], v4 offset:33920
    v_mfma_f32_16x16x32_bf16 v[160:163], v[52:55], v[32:35], v[160:163]
    ds_read_b64 v[90:91], v4 offset:36032
    v_mfma_f32_16x16x32_bf16 v[176:179], v[56:59], v[32:35], v[176:179]
    ds_read_b64_tr_b16 v[92:93], v6 offset:33536
    v_mfma_f32_16x16x32_bf16 v[180:183], v[56:59], v[36:39], v[180:183]
    ds_read_b64_tr_b16 v[94:95], v6 offset:34560
    v_mfma_f32_16x16x32_bf16 v[184:187], v[56:59], v[40:43], v[184:187]
    ds_read_b64_tr_b16 v[96:97], v7 offset:33536
    v_mfma_f32_16x16x32_bf16 v[188:191], v[56:59], v[44:47], v[188:191]
    ds_read_b64_tr_b16 v[98:99], v7 offset:34560
    v_mfma_f32_16x16x32_bf16 v[204:207], v[60:63], v[44:47], v[204:207]
    ds_read_b64_tr_b16 v[100:101], v8 offset:33536
    v_mfma_f32_16x16x32_bf16 v[200:203], v[60:63], v[40:43], v[200:203]
    ds_read_b64_tr_b16 v[102:103], v8 offset:34560
    v_mfma_f32_16x16x32_bf16 v[196:199], v[60:63], v[36:39], v[196:199]
    ds_read_b64_tr_b16 v[104:105], v6 offset:41744
    v_mfma_f32_16x16x32_bf16 v[192:195], v[60:63], v[32:35], v[192:195]
    ds_read_b64_tr_b16 v[106:107], v6 offset:42768
    v_mfma_f32_16x16x32_bf16 v[208:211], v[64:67], v[32:35], v[208:211]
    ds_read_b64_tr_b16 v[108:109], v7 offset:41744
    v_mfma_f32_16x16x32_bf16 v[212:215], v[64:67], v[36:39], v[212:215]
    ds_read_b64_tr_b16 v[110:111], v7 offset:42768
    v_mfma_f32_16x16x32_bf16 v[216:219], v[64:67], v[40:43], v[216:219]
    ds_read_b64_tr_b16 v[112:113], v8 offset:41744
    v_mfma_f32_16x16x32_bf16 v[220:223], v[64:67], v[44:47], v[220:223]
    ds_read_b64_tr_b16 v[114:115], v8 offset:42768
    v_mfma_f32_16x16x32_bf16 v[236:239], v[68:71], v[44:47], v[236:239]
    ds_read_b64_tr_b16 v[116:117], v9 offset:33536
    v_mfma_f32_16x16x32_bf16 v[232:235], v[68:71], v[40:43], v[232:235]
    ds_read_b64_tr_b16 v[118:119], v9 offset:34560
    v_mfma_f32_16x16x32_bf16 v[228:231], v[68:71], v[36:39], v[228:231]
    v_mfma_f32_16x16x32_bf16 v[224:227], v[68:71], v[32:35], v[224:227]
    v_mfma_f32_16x16x32_bf16 v[240:243], v[72:75], v[32:35], v[240:243]
    v_mfma_f32_16x16x32_bf16 v[244:247], v[72:75], v[36:39], v[244:247]
    v_mfma_f32_16x16x32_bf16 v[248:251], v[72:75], v[40:43], v[248:251]
    v_mfma_f32_16x16x32_bf16 v[252:255], v[72:75], v[44:47], v[252:255]
    s_waitcnt vmcnt(1) lgkmcnt(0)
    s_barrier
    v_mfma_f32_16x16x32_bf16 v[144:147], v[92:95], v[76:79], v[144:147]
    ds_read_b64 v[32:33], v5 offset:0
    v_mfma_f32_16x16x32_bf16 v[148:151], v[92:95], v[80:83], v[148:151]
    ds_read_b64 v[34:35], v5 offset:2112
    v_mfma_f32_16x16x32_bf16 v[152:155], v[92:95], v[84:87], v[152:155]
    ds_read_b64 v[36:37], v5 offset:128
    v_mfma_f32_16x16x32_bf16 v[156:159], v[92:95], v[88:91], v[156:159]
    ds_read_b64 v[38:39], v5 offset:2240
    v_mfma_f32_16x16x32_bf16 v[172:175], v[96:99], v[88:91], v[172:175]
    ds_read_b64 v[40:41], v5 offset:256
    v_mfma_f32_16x16x32_bf16 v[168:171], v[96:99], v[84:87], v[168:171]
    ds_read_b64 v[42:43], v5 offset:2368
    v_mfma_f32_16x16x32_bf16 v[164:167], v[96:99], v[80:83], v[164:167]
    ds_read_b64 v[44:45], v5 offset:384
    v_mfma_f32_16x16x32_bf16 v[160:163], v[96:99], v[76:79], v[160:163]
    ds_read_b64 v[46:47], v5 offset:2496
    v_mfma_f32_16x16x32_bf16 v[176:179], v[100:103], v[76:79], v[176:179]
    ds_read_b64_tr_b16 v[48:49], v10 offset:0
    v_mfma_f32_16x16x32_bf16 v[180:183], v[100:103], v[80:83], v[180:183]
    ds_read_b64_tr_b16 v[50:51], v10 offset:1024
    v_mfma_f32_16x16x32_bf16 v[184:187], v[100:103], v[84:87], v[184:187]
    ds_read_b64_tr_b16 v[52:53], v11 offset:0
    v_mfma_f32_16x16x32_bf16 v[188:191], v[100:103], v[88:91], v[188:191]
    ds_read_b64_tr_b16 v[54:55], v11 offset:1024
    v_mfma_f32_16x16x32_bf16 v[204:207], v[104:107], v[88:91], v[204:207]
    ds_read_b64_tr_b16 v[56:57], v12 offset:0
    v_mfma_f32_16x16x32_bf16 v[200:203], v[104:107], v[84:87], v[200:203]
    ds_read_b64_tr_b16 v[58:59], v12 offset:1024
    v_mfma_f32_16x16x32_bf16 v[196:199], v[104:107], v[80:83], v[196:199]
    ds_read_b64_tr_b16 v[60:61], v10 offset:8208
    v_mfma_f32_16x16x32_bf16 v[192:195], v[104:107], v[76:79], v[192:195]
    ds_read_b64_tr_b16 v[62:63], v10 offset:9232
    v_mfma_f32_16x16x32_bf16 v[208:211], v[108:111], v[76:79], v[208:211]
    ds_read_b64_tr_b16 v[64:65], v11 offset:8208
    v_mfma_f32_16x16x32_bf16 v[212:215], v[108:111], v[80:83], v[212:215]
    ds_read_b64_tr_b16 v[66:67], v11 offset:9232
    v_mfma_f32_16x16x32_bf16 v[216:219], v[108:111], v[84:87], v[216:219]
    ds_read_b64_tr_b16 v[68:69], v12 offset:8208
    v_mfma_f32_16x16x32_bf16 v[220:223], v[108:111], v[88:91], v[220:223]
    ds_read_b64_tr_b16 v[70:71], v12 offset:9232
    v_mfma_f32_16x16x32_bf16 v[236:239], v[112:115], v[88:91], v[236:239]
    ds_read_b64_tr_b16 v[72:73], v13 offset:0
    v_mfma_f32_16x16x32_bf16 v[232:235], v[112:115], v[84:87], v[232:235]
    ds_read_b64_tr_b16 v[74:75], v13 offset:1024
    v_mfma_f32_16x16x32_bf16 v[228:231], v[112:115], v[80:83], v[228:231]
    v_mfma_f32_16x16x32_bf16 v[224:227], v[112:115], v[76:79], v[224:227]
    v_mfma_f32_16x16x32_bf16 v[240:243], v[116:119], v[76:79], v[240:243]
    v_mfma_f32_16x16x32_bf16 v[244:247], v[116:119], v[80:83], v[244:247]
    v_mfma_f32_16x16x32_bf16 v[248:251], v[116:119], v[84:87], v[248:251]
    v_mfma_f32_16x16x32_bf16 v[252:255], v[116:119], v[88:91], v[252:255]
    s_waitcnt lgkmcnt(0)
    buffer_load_dwordx4 v[120:123], v132, s[56:59], 0 offen offset:0 sc1
    buffer_load_dwordx4 v[124:127], v132, s[56:59], 0 offen offset:256 sc1
    buffer_load_dwordx4 v[128:131], v132, s[56:59], 0 offen offset:512 sc1
    v_mfma_f32_16x16x32_bf16 v[144:147], v[48:51], v[32:35], v[144:147]
    ds_read_b64 v[76:77], v5 offset:33536
    v_mfma_f32_16x16x32_bf16 v[148:151], v[48:51], v[36:39], v[148:151]
    ds_read_b64 v[78:79], v5 offset:35648
    v_mfma_f32_16x16x32_bf16 v[152:155], v[48:51], v[40:43], v[152:155]
    ds_read_b64 v[80:81], v5 offset:33664
    v_mfma_f32_16x16x32_bf16 v[156:159], v[48:51], v[44:47], v[156:159]
    ds_read_b64 v[82:83], v5 offset:35776
    v_mfma_f32_16x16x32_bf16 v[172:175], v[52:55], v[44:47], v[172:175]
    ds_read_b64 v[84:85], v5 offset:33792
    v_mfma_f32_16x16x32_bf16 v[168:171], v[52:55], v[40:43], v[168:171]
    ds_read_b64 v[86:87], v5 offset:35904
    v_mfma_f32_16x16x32_bf16 v[164:167], v[52:55], v[36:39], v[164:167]
    ds_read_b64 v[88:89], v5 offset:33920
    v_mfma_f32_16x16x32_bf16 v[160:163], v[52:55], v[32:35], v[160:163]
    ds_read_b64 v[90:91], v5 offset:36032
    v_mfma_f32_16x16x32_bf16 v[176:179], v[56:59], v[32:35], v[176:179]
    ds_read_b64_tr_b16 v[92:93], v10 offset:33536
    v_mfma_f32_16x16x32_bf16 v[180:183], v[56:59], v[36:39], v[180:183]
    ds_read_b64_tr_b16 v[94:95], v10 offset:34560
    v_mfma_f32_16x16x32_bf16 v[184:187], v[56:59], v[40:43], v[184:187]
    ds_read_b64_tr_b16 v[96:97], v11 offset:33536
    v_mfma_f32_16x16x32_bf16 v[188:191], v[56:59], v[44:47], v[188:191]
    ds_read_b64_tr_b16 v[98:99], v11 offset:34560
    v_mfma_f32_16x16x32_bf16 v[204:207], v[60:63], v[44:47], v[204:207]
    ds_read_b64_tr_b16 v[100:101], v12 offset:33536
    v_mfma_f32_16x16x32_bf16 v[200:203], v[60:63], v[40:43], v[200:203]
    ds_read_b64_tr_b16 v[102:103], v12 offset:34560
    v_mfma_f32_16x16x32_bf16 v[196:199], v[60:63], v[36:39], v[196:199]
    ds_read_b64_tr_b16 v[104:105], v10 offset:41744
    v_mfma_f32_16x16x32_bf16 v[192:195], v[60:63], v[32:35], v[192:195]
    ds_read_b64_tr_b16 v[106:107], v10 offset:42768
    v_mfma_f32_16x16x32_bf16 v[208:211], v[64:67], v[32:35], v[208:211]
    ds_read_b64_tr_b16 v[108:109], v11 offset:41744
    v_mfma_f32_16x16x32_bf16 v[212:215], v[64:67], v[36:39], v[212:215]
    ds_read_b64_tr_b16 v[110:111], v11 offset:42768
    v_mfma_f32_16x16x32_bf16 v[216:219], v[64:67], v[40:43], v[216:219]
    ds_read_b64_tr_b16 v[112:113], v12 offset:41744
    v_mfma_f32_16x16x32_bf16 v[220:223], v[64:67], v[44:47], v[220:223]
    ds_read_b64_tr_b16 v[114:115], v12 offset:42768
    v_mfma_f32_16x16x32_bf16 v[236:239], v[68:71], v[44:47], v[236:239]
    ds_read_b64_tr_b16 v[116:117], v13 offset:33536
    v_mfma_f32_16x16x32_bf16 v[232:235], v[68:71], v[40:43], v[232:235]
    ds_read_b64_tr_b16 v[118:119], v13 offset:34560
    v_mfma_f32_16x16x32_bf16 v[228:231], v[68:71], v[36:39], v[228:231]
    v_mfma_f32_16x16x32_bf16 v[224:227], v[68:71], v[32:35], v[224:227]
    v_mfma_f32_16x16x32_bf16 v[240:243], v[72:75], v[32:35], v[240:243]
    v_mfma_f32_16x16x32_bf16 v[244:247], v[72:75], v[36:39], v[244:247]
    v_mfma_f32_16x16x32_bf16 v[248:251], v[72:75], v[40:43], v[248:251]
    v_mfma_f32_16x16x32_bf16 v[252:255], v[72:75], v[44:47], v[252:255]
    s_waitcnt lgkmcnt(0)
    buffer_load_dwordx4 v[64:67], v132, s[56:59], 0 offen offset:768 sc1
    buffer_load_dwordx4 v[68:71], v133, s[56:59], 0 offen offset:0 sc1
    buffer_load_dwordx4 v[72:75], v133, s[56:59], 0 offen offset:512 sc1
    v_mfma_f32_16x16x32_bf16 v[144:147], v[92:95], v[76:79], v[144:147]
    ds_read_b128 v[32:35], v20 offset:0
    v_mfma_f32_16x16x32_bf16 v[148:151], v[92:95], v[80:83], v[148:151]
    ds_read_b128 v[44:47], v20 offset:448
    v_mfma_f32_16x16x32_bf16 v[152:155], v[92:95], v[84:87], v[152:155]
    ds_read_b128 v[36:39], v20 offset:64
    v_mfma_f32_16x16x32_bf16 v[156:159], v[92:95], v[88:91], v[156:159]
    ds_read_b128 v[48:51], v20 offset:512
    v_mfma_f32_16x16x32_bf16 v[172:175], v[96:99], v[88:91], v[172:175]
    ds_read_b128 v[40:43], v20 offset:128
    v_mfma_f32_16x16x32_bf16 v[168:171], v[96:99], v[84:87], v[168:171]
    ds_read_b128 v[52:55], v20 offset:576
    v_mfma_f32_16x16x32_bf16 v[164:167], v[96:99], v[80:83], v[164:167]
    ds_read_b128 v[56:59], v21
    v_mfma_f32_16x16x32_bf16 v[160:163], v[96:99], v[76:79], v[160:163]
    ds_read_b128 v[60:63], v21 offset:448
    v_mfma_f32_16x16x32_bf16 v[176:179], v[100:103], v[76:79], v[176:179]
    v_mfma_f32_16x16x32_bf16 v[180:183], v[100:103], v[80:83], v[180:183]
    v_mfma_f32_16x16x32_bf16 v[184:187], v[100:103], v[84:87], v[184:187]
    v_mfma_f32_16x16x32_bf16 v[188:191], v[100:103], v[88:91], v[188:191]
    v_mfma_f32_16x16x32_bf16 v[204:207], v[104:107], v[88:91], v[204:207]
    v_mfma_f32_16x16x32_bf16 v[200:203], v[104:107], v[84:87], v[200:203]
    v_mfma_f32_16x16x32_bf16 v[196:199], v[104:107], v[80:83], v[196:199]
    v_mfma_f32_16x16x32_bf16 v[192:195], v[104:107], v[76:79], v[192:195]
    v_mfma_f32_16x16x32_bf16 v[208:211], v[108:111], v[76:79], v[208:211]
    v_mfma_f32_16x16x32_bf16 v[212:215], v[108:111], v[80:83], v[212:215]
    v_mfma_f32_16x16x32_bf16 v[216:219], v[108:111], v[84:87], v[216:219]
    v_mfma_f32_16x16x32_bf16 v[220:223], v[108:111], v[88:91], v[220:223]
    v_mfma_f32_16x16x32_bf16 v[236:239], v[112:115], v[88:91], v[236:239]
    v_mfma_f32_16x16x32_bf16 v[232:235], v[112:115], v[84:87], v[232:235]
    v_mfma_f32_16x16x32_bf16 v[228:231], v[112:115], v[80:83], v[228:231]
    v_mfma_f32_16x16x32_bf16 v[224:227], v[112:115], v[76:79], v[224:227]
    v_mfma_f32_16x16x32_bf16 v[240:243], v[116:119], v[76:79], v[240:243]
    v_mfma_f32_16x16x32_bf16 v[244:247], v[116:119], v[80:83], v[244:247]
    v_mfma_f32_16x16x32_bf16 v[248:251], v[116:119], v[84:87], v[248:251]
    v_mfma_f32_16x16x32_bf16 v[252:255], v[116:119], v[88:91], v[252:255]
    s_cmp_ge_u32 s30, 4
    s_cbranch_scc1 L_g1_eb1
    s_barrier
L_g1_eb1:
    s_add_u32 s24, s8, 0x01800000
    s_addc_u32 s25, s9, 0
    s_mov_b32 s26, 0x00e00000
    s_mov_b32 s27, 0x00020000
    s_mov_b32 s53, 0
    s_mov_b32 s50, 0
    s_mov_b32 s51, 65536
    s_mov_b32 s52, 131072
L_g1_poll:
    s_waitcnt vmcnt(0)
    v_or3_b32 v22, v120, v121, v122
    v_or3_b32 v23, v123, v124, v125
    v_or3_b32 v23, v23, v126, v127
    v_or3_b32 v22, v22, v128, v129
    v_or3_b32 v23, v23, v130, v131
    v_or3_b32 v22, v22, v64, v65
    v_or3_b32 v23, v23, v66, v67
    v_or3_b32 v22, v22, v68, v69
    v_or3_b32 v23, v23, v70, v71
    v_or3_b32 v22, v22, v72, v73
    v_or3_b32 v23, v23, v74, v75
    v_or_b32 v22, v22, v23
    v_and_b32 v22, 1, v22
    v_cmp_ne_u32 vcc, 0, v22
    s_add_u32 s53, s53, 1
    s_cbranch_vccz L_g1_ready
    s_cmp_ge_u32 s53, 0x40000
    s_cbranch_scc1 L_g1_ready
    s_sleep 2
    buffer_load_dwordx4 v[120:123], v132, s[56:59], 0 offen offset:0 sc1
    buffer_load_dwordx4 v[124:127], v132, s[56:59], 0 offen offset:256 sc1
    buffer_load_dwordx4 v[128:131], v132, s[56:59], 0 offen offset:512 sc1
    buffer_load_dwordx4 v[64:67], v132, s[56:59], 0 offen offset:768 sc1
    buffer_load_dwordx4 v[68:71], v133, s[56:59], 0 offen offset:0 sc1
    buffer_load_dwordx4 v[72:75], v133, s[56:59], 0 offen offset:512 sc1
    s_branch L_g1_poll
L_g1_ready:
    s_waitcnt lgkmcnt(0)
    v_permlane32_swap_b32 v240, v244
    v_permlane32_swap_b32 v241, v245
    v_permlane32_swap_b32 v242, v246
    v_permlane32_swap_b32 v243, v247
    v_permlane32_swap_b32 v248, v252
    v_permlane32_swap_b32 v249, v253
    v_permlane32_swap_b32 v250, v254
    v_permlane32_swap_b32 v251, v255
    s_cmp_ge_u32 s30, 4
    s_cbranch_scc0 L_g1_eb2
    s_setprio 0
    v_fma_f32 v144, -v32, v120, v144
    v_fma_f32 v145, -v33, v120, v145
    v_fma_f32 v146, -v34, v120, v146
    v_fma_f32 v147, -v35, v120, v147
    v_fma_f32 v148, -v32, v124, v148
    v_fma_f32 v149, -v33, v124, v149
    v_fma_f32 v150, -v34, v124, v150
    v_fma_f32 v151, -v35, v124, v151
    v_fma_f32 v152, -v32, v128, v152
    v_fma_f32 v153, -v33, v128, v153
    v_fma_f32 v154, -v34, v128, v154
    v_fma_f32 v155, -v35, v128, v155
    v_fma_f32 v156, -v32, v64, v156
    v_fma_f32 v157, -v33, v64, v157
    v_fma_f32 v158, -v34, v64, v158
    v_fma_f32 v159, -v35, v64, v159
    v_fma_f32 v160, -v36, v120, v160
    v_fma_f32 v161, -v37, v120, v161
    v_fma_f32 v162, -v38, v120, v162
    v_fma_f32 v163, -v39, v120, v163
    v_fma_f32 v164, -v36, v124, v164
    v_fma_f32 v165, -v37, v124, v165
    v_fma_f32 v166, -v38, v124, v166
    v_fma_f32 v167, -v39, v124, v167
    v_fma_f32 v168, -v36, v128, v168
    v_fma_f32 v169, -v37, v128, v169
    v_fma_f32 v170, -v38, v128, v170
    v_fma_f32 v171, -v39, v128, v171
    v_fma_f32 v172, -v36, v64, v172
    v_fma_f32 v173, -v37, v64, v173
    v_fma_f32 v174, -v38, v64, v174
    v_fma_f32 v175, -v39, v64, v175
    v_fma_f32 v176, -v40, v120, v176
    v_fma_f32 v177, -v41, v120, v177
    v_fma_f32 v178, -v42, v120, v178
    v_fma_f32 v179, -v43, v120, v179
    v_fma_f32 v180, -v40, v124, v180
    v_fma_f32 v181, -v41, v124, v181
    v_fma_f32 v182, -v42, v124, v182
    v_fma_f32 v183, -v43, v124, v183
    v_fma_f32 v184, -v40, v128, v184
    v_fma_f32 v185, -v41, v128, v185
    v_fma_f32 v186, -v42, v128, v186
    v_fma_f32 v187, -v43, v128, v187
    v_fma_f32 v188, -v40, v64, v188
    v_fma_f32 v189, -v41, v64, v189
    v_fma_f32 v190, -v42, v64, v190
    v_fma_f32 v191, -v43, v64, v191
    v_fma_f32 v192, -v44, v120, v192
    v_fma_f32 v193, -v45, v120, v193
    v_fma_f32 v194, -v46, v120, v194
    v_fma_f32 v195, -v47, v120, v195
    v_fma_f32 v196, -v44, v124, v196
    v_fma_f32 v197, -v45, v124, v197
    v_fma_f32 v198, -v46, v124, v198
    v_fma_f32 v199, -v47, v124, v199
    v_fma_f32 v200, -v44, v128, v200
    v_fma_f32 v201, -v45, v128, v201
    v_fma_f32 v202, -v46, v128, v202
    v_fma_f32 v203, -v47, v128, v203
    v_fma_f32 v204, -v44, v64, v204
    v_fma_f32 v205, -v45, v64, v205
    v_fma_f32 v206, -v46, v64, v206
    v_fma_f32 v207, -v47, v64, v207
    v_fma_f32 v208, -v48, v120, v208
    v_fma_f32 v209, -v49, v120, v209
    v_fma_f32 v210, -v50, v120, v210
    v_fma_f32 v211, -v51, v120, v211
    v_fma_f32 v212, -v48, v124, v212
    v_fma_f32 v213, -v49, v124, v213
    v_fma_f32 v214, -v50, v124, v214
    v_fma_f32 v215, -v51, v124, v215
    v_fma_f32 v216, -v48, v128, v216
    v_fma_f32 v217, -v49, v128, v217
    v_fma_f32 v218, -v50, v128, v218
    v_fma_f32 v219, -v51, v128, v219
    v_fma_f32 v220, -v48, v64, v220
    v_fma_f32 v221, -v49, v64, v221
    v_fma_f32 v222, -v50, v64, v222
    v_fma_f32 v223, -v51, v64, v223
    v_fma_f32 v224, -v52, v120, v224
    v_fma_f32 v225, -v53, v120, v225
    v_fma_f32 v226, -v54, v120, v226
    v_fma_f32 v227, -v55, v120, v227
    v_fma_f32 v228, -v52, v124, v228
    v_fma_f32 v229, -v53, v124, v229
    v_fma_f32 v230, -v54, v124, v230
    v_fma_f32 v231, -v55, v124, v231
    v_fma_f32 v232, -v52, v128, v232
    v_fma_f32 v233, -v53, v128, v233
    v_fma_f32 v234, -v54, v128, v234
    v_fma_f32 v235, -v55, v128, v235
    v_fma_f32 v236, -v52, v64, v236
    v_fma_f32 v237, -v53, v64, v237
    v_fma_f32 v238, -v54, v64, v238
    v_fma_f32 v239, -v55, v64, v239
    v_fma_f32 v240, -v56, v68, v240
    v_fma_f32 v241, -v57, v68, v241
    v_fma_f32 v242, -v58, v68, v242
    v_fma_f32 v243, -v59, v68, v243
    v_fma_f32 v244, -v60, v68, v244
    v_fma_f32 v245, -v61, v68, v245
    v_fma_f32 v246, -v62, v68, v246
    v_fma_f32 v247, -v63, v68, v247
    v_fma_f32 v248, -v56, v72, v248
    v_fma_f32 v249, -v57, v72, v249
    v_fma_f32 v250, -v58, v72, v250
    v_fma_f32 v251, -v59, v72, v251
    v_fma_f32 v252, -v60, v72, v252
    v_fma_f32 v253, -v61, v72, v253
    v_fma_f32 v254, -v62, v72, v254
    v_fma_f32 v255, -v63, v72, v255
    s_setprio 1
    s_barrier
    s_nop 6
    s_branch L_g1_eb3
L_g1_eb2:
    v_pk_fma_f32 v[144:145], v[32:33], v[120:121], v[144:145] op_sel_hi:[1,0,1] neg_lo:[0,1,0] neg_hi:[0,1,0]
    v_pk_fma_f32 v[146:147], v[34:35], v[120:121], v[146:147] op_sel_hi:[1,0,1] neg_lo:[0,1,0] neg_hi:[0,1,0]
    v_pk_fma_f32 v[148:149], v[32:33], v[124:125], v[148:149] op_sel_hi:[1,0,1] neg_lo:[0,1,0] neg_hi:[0,1,0]
    v_pk_fma_f32 v[150:151], v[34:35], v[124:125], v[150:151] op_sel_hi:[1,0,1] neg_lo:[0,1,0] neg_hi:[0,1,0]
    v_pk_fma_f32 v[152:153], v[32:33], v[128:129], v[152:153] op_sel_hi:[1,0,1] neg_lo:[0,1,0] neg_hi:[0,1,0]
    v_pk_fma_f32 v[154:155], v[34:35], v[128:129], v[154:155] op_sel_hi:[1,0,1] neg_lo:[0,1,0] neg_hi:[0,1,0]
    v_pk_fma_f32 v[156:157], v[32:33], v[64:65], v[156:157] op_sel_hi:[1,0,1] neg_lo:[0,1,0] neg_hi:[0,1,0]
    v_pk_fma_f32 v[158:159], v[34:35], v[64:65], v[158:159] op_sel_hi:[1,0,1] neg_lo:[0,1,0] neg_hi:[0,1,0]
    v_pk_fma_f32 v[160:161], v[36:37], v[120:121], v[160:161] op_sel_hi:[1,0,1] neg_lo:[0,1,0] neg_hi:[0,1,0]
    v_pk_fma_f32 v[162:163], v[38:39], v[120:121], v[162:163] op_sel_hi:[1,0,1] neg_lo:[0,1,0] neg_hi:[0,1,0]
    v_pk_fma_f32 v[164:165], v[36:37], v[124:125], v[164:165] op_sel_hi:[1,0,1] neg_lo:[0,1,0] neg_hi:[0,1,0]
    v_pk_fma_f32 v[166:167], v[38:39], v[124:125], v[166:167] op_sel_hi:[1,0,1] neg_lo:[0,1,0] neg_hi:[0,1,0]
    v_pk_fma_f32 v[168:169], v[36:37], v[128:129], v[168:169] op_sel_hi:[1,0,1] neg_lo:[0,1,0] neg_hi:[0,1,0]
    v_pk_fma_f32 v[170:171], v[38:39], v[128:129], v[170:171] op_sel_hi:[1,0,1] neg_lo:[0,1,0] neg_hi:[0,1,0]
    v_pk_fma_f32 v[172:173], v[36:37], v[64:65], v[172:173] op_sel_hi:[1,0,1] neg_lo:[0,1,0] neg_hi:[0,1,0]
    v_pk_fma_f32 v[174:175], v[38:39], v[64:65], v[174:175] op_sel_hi:[1,0,1] neg_lo:[0,1,0] neg_hi:[0,1,0]
    v_pk_fma_f32 v[176:177], v[40:41], v[120:121], v[176:177] op_sel_hi:[1,0,1] neg_lo:[0,1,0] neg_hi:[0,1,0]
    v_pk_fma_f32 v[178:179], v[42:43], v[120:121], v[178:179] op_sel_hi:[1,0,1] neg_lo:[0,1,0] neg_hi:[0,1,0]
    v_pk_fma_f32 v[180:181], v[40:41], v[124:125], v[180:181] op_sel_hi:[1,0,1] neg_lo:[0,1,0] neg_hi:[0,1,0]
    v_pk_fma_f32 v[182:183], v[42:43], v[124:125], v[182:183] op_sel_hi:[1,0,1] neg_lo:[0,1,0] neg_hi:[0,1,0]
    v_pk_fma_f32 v[184:185], v[40:41], v[128:129], v[184:185] op_sel_hi:[1,0,1] neg_lo:[0,1,0] neg_hi:[0,1,0]
    v_pk_fma_f32 v[186:187], v[42:43], v[128:129], v[186:187] op_sel_hi:[1,0,1] neg_lo:[0,1,0] neg_hi:[0,1,0]
    v_pk_fma_f32 v[188:189], v[40:41], v[64:65], v[188:189] op_sel_hi:[1,0,1] neg_lo:[0,1,0] neg_hi:[0,1,0]
    v_pk_fma_f32 v[190:191], v[42:43], v[64:65], v[190:191] op_sel_hi:[1,0,1] neg_lo:[0,1,0] neg_hi:[0,1,0]
    v_pk_fma_f32 v[192:193], v[44:45], v[120:121], v[192:193] op_sel_hi:[1,0,1] neg_lo:[0,1,0] neg_hi:[0,1,0]
    v_pk_fma_f32 v[194:195], v[46:47], v[120:121], v[194:195] op_sel_hi:[1,0,1] neg_lo:[0,1,0] neg_hi:[0,1,0]
    v_pk_fma_f32 v[196:197], v[44:45], v[124:125], v[196:197] op_sel_hi:[1,0,1] neg_lo:[0,1,0] neg_hi:[0,1,0]
    v_pk_fma_f32 v[198:199], v[46:47], v[124:125], v[198:199] op_sel_hi:[1,0,1] neg_lo:[0,1,0] neg_hi:[0,1,0]
    v_pk_fma_f32 v[200:201], v[44:45], v[128:129], v[200:201] op_sel_hi:[1,0,1] neg_lo:[0,1,0] neg_hi:[0,1,0]
    v_pk_fma_f32 v[202:203], v[46:47], v[128:129], v[202:203] op_sel_hi:[1,0,1] neg_lo:[0,1,0] neg_hi:[0,1,0]
    v_pk_fma_f32 v[204:205], v[44:45], v[64:65], v[204:205] op_sel_hi:[1,0,1] neg_lo:[0,1,0] neg_hi:[0,1,0]
    v_pk_fma_f32 v[206:207], v[46:47], v[64:65], v[206:207] op_sel_hi:[1,0,1] neg_lo:[0,1,0] neg_hi:[0,1,0]
    v_pk_fma_f32 v[208:209], v[48:49], v[120:121], v[208:209] op_sel_hi:[1,0,1] neg_lo:[0,1,0] neg_hi:[0,1,0]
    v_pk_fma_f32 v[210:211], v[50:51], v[120:121], v[210:211] op_sel_hi:[1,0,1] neg_lo:[0,1,0] neg_hi:[0,1,0]
    v_pk_fma_f32 v[212:213], v[48:49], v[124:125], v[212:213] op_sel_hi:[1,0,1] neg_lo:[0,1,0] neg_hi:[0,1,0]
    v_pk_fma_f32 v[214:215], v[50:51], v[124:125], v[214:215] op_sel_hi:[1,0,1] neg_lo:[0,1,0] neg_hi:[0,1,0]
    v_pk_fma_f32 v[216:217], v[48:49], v[128:129], v[216:217] op_sel_hi:[1,0,1] neg_lo:[0,1,0] neg_hi:[0,1,0]
    v_pk_fma_f32 v[218:219], v[50:51], v[128:129], v[218:219] op_sel_hi:[1,0,1] neg_lo:[0,1,0] neg_hi:[0,1,0]
    v_pk_fma_f32 v[220:221], v[48:49], v[64:65], v[220:221] op_sel_hi:[1,0,1] neg_lo:[0,1,0] neg_hi:[0,1,0]
    v_pk_fma_f32 v[222:223], v[50:51], v[64:65], v[222:223] op_sel_hi:[1,0,1] neg_lo:[0,1,0] neg_hi:[0,1,0]
    v_pk_fma_f32 v[224:225], v[52:53], v[120:121], v[224:225] op_sel_hi:[1,0,1] neg_lo:[0,1,0] neg_hi:[0,1,0]
    v_pk_fma_f32 v[226:227], v[54:55], v[120:121], v[226:227] op_sel_hi:[1,0,1] neg_lo:[0,1,0] neg_hi:[0,1,0]
    v_pk_fma_f32 v[228:229], v[52:53], v[124:125], v[228:229] op_sel_hi:[1,0,1] neg_lo:[0,1,0] neg_hi:[0,1,0]
    v_pk_fma_f32 v[230:231], v[54:55], v[124:125], v[230:231] op_sel_hi:[1,0,1] neg_lo:[0,1,0] neg_hi:[0,1,0]
    v_pk_fma_f32 v[232:233], v[52:53], v[128:129], v[232:233] op_sel_hi:[1,0,1] neg_lo:[0,1,0] neg_hi:[0,1,0]
    v_pk_fma_f32 v[234:235], v[54:55], v[128:129], v[234:235] op_sel_hi:[1,0,1] neg_lo:[0,1,0] neg_hi:[0,1,0]
    v_pk_fma_f32 v[236:237], v[52:53], v[64:65], v[236:237] op_sel_hi:[1,0,1] neg_lo:[0,1,0] neg_hi:[0,1,0]
    v_pk_fma_f32 v[238:239], v[54:55], v[64:65], v[238:239] op_sel_hi:[1,0,1] neg_lo:[0,1,0] neg_hi:[0,1,0]
    v_pk_fma_f32 v[240:241], v[56:57], v[68:69], v[240:241] op_sel_hi:[1,0,1] neg_lo:[0,1,0] neg_hi:[0,1,0]
    v_pk_fma_f32 v[242:243], v[58:59], v[68:69], v[242:243] op_sel_hi:[1,0,1] neg_lo:[0,1,0] neg_hi:[0,1,0]
    v_pk_fma_f32 v[244:245], v[60:61], v[68:69], v[244:245] op_sel_hi:[1,0,1] neg_lo:[0,1,0] neg_hi:[0,1,0]
    v_pk_fma_f32 v[246:247], v[62:63], v[68:69], v[246:247] op_sel_hi:[1,0,1] neg_lo:[0,1,0] neg_hi:[0,1,0]
    v_pk_fma_f32 v[248:249], v[56:57], v[72:73], v[248:249] op_sel_hi:[1,0,1] neg_lo:[0,1,0] neg_hi:[0,1,0]
    v_pk_fma_f32 v[250:251], v[58:59], v[72:73], v[250:251] op_sel_hi:[1,0,1] neg_lo:[0,1,0] neg_hi:[0,1,0]
    v_pk_fma_f32 v[252:253], v[60:61], v[72:73], v[252:253] op_sel_hi:[1,0,1] neg_lo:[0,1,0] neg_hi:[0,1,0]
    v_pk_fma_f32 v[254:255], v[62:63], v[72:73], v[254:255] op_sel_hi:[1,0,1] neg_lo:[0,1,0] neg_hi:[0,1,0]
L_g1_eb3:
    v_pk_mul_f32 v[76:77], v[144:145], v[144:145]
    v_pk_mul_f32 v[78:79], v[146:147], v[146:147]
    v_pk_fma_f32 v[76:77], v[76:77], v[122:123], v[122:123] op_sel:[0,1,0] op_sel_hi:[1,1,0]
    v_pk_fma_f32 v[78:79], v[78:79], v[122:123], v[122:123] op_sel:[0,1,0] op_sel_hi:[1,1,0]
    v_pk_mul_f32 v[76:77], v[76:77], v[144:145]
    v_pk_mul_f32 v[78:79], v[78:79], v[146:147]
    v_exp_f32 v76, v76
    v_exp_f32 v77, v77
    v_exp_f32 v78, v78
    v_exp_f32 v79, v79
    v_pk_mul_f32 v[144:145], v[144:145], v[192:193]
    v_pk_mul_f32 v[146:147], v[146:147], v[194:195]
    v_pk_fma_f32 v[76:77], v[76:77], v[120:121], v[120:121] op_sel:[0,1,1] op_sel_hi:[1,1,1]
    v_pk_fma_f32 v[78:79], v[78:79], v[120:121], v[120:121] op_sel:[0,1,1] op_sel_hi:[1,1,1]
    v_rcp_f32 v76, v76
    v_rcp_f32 v77, v77
    v_rcp_f32 v78, v78
    v_rcp_f32 v79, v79
    v_pk_mul_f32 v[76:77], v[76:77], v[144:145]
    v_pk_mul_f32 v[78:79], v[78:79], v[146:147]
    v_cvt_pk_bf16_f32 v84, v76, v77
    v_cvt_pk_bf16_f32 v85, v78, v79
    v_pk_mul_f32 v[80:81], v[148:149], v[148:149]
    v_pk_mul_f32 v[82:83], v[150:151], v[150:151]
    v_pk_fma_f32 v[80:81], v[80:81], v[126:127], v[126:127] op_sel:[0,1,0] op_sel_hi:[1,1,0]
    v_pk_fma_f32 v[82:83], v[82:83], v[126:127], v[126:127] op_sel:[0,1,0] op_sel_hi:[1,1,0]
    v_pk_mul_f32 v[80:81], v[80:81], v[148:149]
    v_pk_mul_f32 v[82:83], v[82:83], v[150:151]
    v_exp_f32 v80, v80
    v_exp_f32 v81, v81
    v_exp_f32 v82, v82
    v_exp_f32 v83, v83
    v_pk_mul_f32 v[148:149], v[148:149], v[196:197]
    v_pk_mul_f32 v[150:151], v[150:151], v[198:199]
    v_pk_fma_f32 v[80:81], v[80:81], v[124:125], v[124:125] op_sel:[0,1,1] op_sel_hi:[1,1,1]
    v_pk_fma_f32 v[82:83], v[82:83], v[124:125], v[124:125] op_sel:[0,1,1] op_sel_hi:[1,1,1]
    v_rcp_f32 v80, v80
    v_rcp_f32 v81, v81
    v_rcp_f32 v82, v82
    v_rcp_f32 v83, v83
    v_pk_mul_f32 v[80:81], v[80:81], v[148:149]
    v_pk_mul_f32 v[82:83], v[82:83], v[150:151]
    v_cvt_pk_bf16_f32 v86, v80, v81
    v_cvt_pk_bf16_f32 v87, v82, v83
    v_pk_mul_f32 v[76:77], v[152:153], v[152:153]
    v_pk_mul_f32 v[78:79], v[154:155], v[154:155]
    v_permlane16_swap_b32 v84, v86
    v_permlane16_swap_b32 v85, v87
    buffer_store_dwordx4 v[84:87], v134, s[24:27], s50 offen offset:0 sc1
    v_pk_fma_f32 v[76:77], v[76:77], v[130:131], v[130:131] op_sel:[0,1,0] op_sel_hi:[1,1,0]
    v_pk_fma_f32 v[78:79], v[78:79], v[130:131], v[130:131] op_sel:[0,1,0] op_sel_hi:[1,1,0]
    v_pk_mul_f32 v[76:77], v[76:77], v[152:153]
    v_pk_mul_f32 v[78:79], v[78:79], v[154:155]
    v_exp_f32 v76, v76
    v_exp_f32 v77, v77
    v_exp_f32 v78, v78
    v_exp_f32 v79, v79
    v_pk_mul_f32 v[152:153], v[152:153], v[200:201]
    v_pk_mul_f32 v[154:155], v[154:155], v[202:203]
    v_pk_fma_f32 v[76:77], v[76:77], v[128:129], v[128:129] op_sel:[0,1,1] op_sel_hi:[1,1,1]
    v_pk_fma_f32 v[78:79], v[78:79], v[128:129], v[128:129] op_sel:[0,1,1] op_sel_hi:[1,1,1]
    v_rcp_f32 v76, v76
    v_rcp_f32 v77, v77
    v_rcp_f32 v78, v78
    v_rcp_f32 v79, v79
    v_pk_mul_f32 v[76:77], v[76:77], v[152:153]
    v_pk_mul_f32 v[78:79], v[78:79], v[154:155]
    v_cvt_pk_bf16_f32 v88, v76, v77
    v_cvt_pk_bf16_f32 v89, v78, v79
    v_pk_mul_f32 v[80:81], v[156:157], v[156:157]
    v_pk_mul_f32 v[82:83], v[158:159], v[158:159]
    v_pk_fma_f32 v[80:81], v[80:81], v[66:67], v[66:67] op_sel:[0,1,0] op_sel_hi:[1,1,0]
    v_pk_fma_f32 v[82:83], v[82:83], v[66:67], v[66:67] op_sel:[0,1,0] op_sel_hi:[1,1,0]
    v_pk_mul_f32 v[80:81], v[80:81], v[156:157]
    v_pk_mul_f32 v[82:83], v[82:83], v[158:159]
    v_exp_f32 v80, v80
    v_exp_f32 v81, v81
    v_exp_f32 v82, v82
    v_exp_f32 v83, v83
    v_pk_mul_f32 v[156:157], v[156:157], v[204:205]
    v_pk_mul_f32 v[158:159], v[158:159], v[206:207]
    v_pk_fma_f32 v[80:81], v[80:81], v[64:65], v[64:65] op_sel:[0,1,1] op_sel_hi:[1,1,1]
    v_pk_fma_f32 v[82:83], v[82:83], v[64:65], v[64:65] op_sel:[0,1,1] op_sel_hi:[1,1,1]
    v_rcp_f32 v80, v80
    v_rcp_f32 v81, v81
    v_rcp_f32 v82, v82
    v_rcp_f32 v83, v83
    v_pk_mul_f32 v[80:81], v[80:81], v[156:157]
    v_pk_mul_f32 v[82:83], v[82:83], v[158:159]
    v_cvt_pk_bf16_f32 v90, v80, v81
    v_cvt_pk_bf16_f32 v91, v82, v83
    v_pk_mul_f32 v[76:77], v[160:161], v[160:161]
    v_pk_mul_f32 v[78:79], v[162:163], v[162:163]
    v_permlane16_swap_b32 v88, v90
    v_permlane16_swap_b32 v89, v91
    buffer_store_dwordx4 v[88:91], v134, s[24:27], s50 offen offset:512 sc1
    v_pk_fma_f32 v[76:77], v[76:77], v[122:123], v[122:123] op_sel:[0,1,0] op_sel_hi:[1,1,0]
    v_pk_fma_f32 v[78:79], v[78:79], v[122:123], v[122:123] op_sel:[0,1,0] op_sel_hi:[1,1,0]
    v_pk_mul_f32 v[76:77], v[76:77], v[160:161]
    v_pk_mul_f32 v[78:79], v[78:79], v[162:163]
    v_exp_f32 v76, v76
    v_exp_f32 v77, v77
    v_exp_f32 v78, v78
    v_exp_f32 v79, v79
    v_pk_mul_f32 v[160:161], v[160:161], v[208:209]
    v_pk_mul_f32 v[162:163], v[162:163], v[210:211]
    v_pk_fma_f32 v[76:77], v[76:77], v[120:121], v[120:121] op_sel:[0,1,1] op_sel_hi:[1,1,1]
    v_pk_fma_f32 v[78:79], v[78:79], v[120:121], v[120:121] op_sel:[0,1,1] op_sel_hi:[1,1,1]
    v_rcp_f32 v76, v76
    v_rcp_f32 v77, v77
    v_rcp_f32 v78, v78
    v_rcp_f32 v79, v79
    v_pk_mul_f32 v[76:77], v[76:77], v[160:161]
    v_pk_mul_f32 v[78:79], v[78:79], v[162:163]
    v_cvt_pk_bf16_f32 v92, v76, v77
    v_cvt_pk_bf16_f32 v93, v78, v79
    v_pk_mul_f32 v[80:81], v[164:165], v[164:165]
    v_pk_mul_f32 v[82:83], v[166:167], v[166:167]
    v_pk_fma_f32 v[80:81], v[80:81], v[126:127], v[126:127] op_sel:[0,1,0] op_sel_hi:[1,1,0]
    v_pk_fma_f32 v[82:83], v[82:83], v[126:127], v[126:127] op_sel:[0,1,0] op_sel_hi:[1,1,0]
    v_pk_mul_f32 v[80:81], v[80:81], v[164:165]
    v_pk_mul_f32 v[82:83], v[82:83], v[166:167]
    v_exp_f32 v80, v80
    v_exp_f32 v81, v81
    v_exp_f32 v82, v82
    v_exp_f32 v83, v83
    v_pk_mul_f32 v[164:165], v[164:165], v[212:213]
    v_pk_mul_f32 v[166:167], v[166:167], v[214:215]
    v_pk_fma_f32 v[80:81], v[80:81], v[124:125], v[124:125] op_sel:[0,1,1] op_sel_hi:[1,1,1]
    v_pk_fma_f32 v[82:83], v[82:83], v[124:125], v[124:125] op_sel:[0,1,1] op_sel_hi:[1,1,1]
    v_rcp_f32 v80, v80
    v_rcp_f32 v81, v81
    v_rcp_f32 v82, v82
    v_rcp_f32 v83, v83
    v_pk_mul_f32 v[80:81], v[80:81], v[164:165]
    v_pk_mul_f32 v[82:83], v[82:83], v[166:167]
    v_cvt_pk_bf16_f32 v94, v80, v81
    v_cvt_pk_bf16_f32 v95, v82, v83
    v_pk_mul_f32 v[76:77], v[168:169], v[168:169]
    v_pk_mul_f32 v[78:79], v[170:171], v[170:171]
    v_permlane16_swap_b32 v92, v94
    v_permlane16_swap_b32 v93, v95
    buffer_store_dwordx4 v[92:95], v134, s[24:27], s51 offen offset:0 sc1
    v_pk_fma_f32 v[76:77], v[76:77], v[130:131], v[130:131] op_sel:[0,1,0] op_sel_hi:[1,1,0]
    v_pk_fma_f32 v[78:79], v[78:79], v[130:131], v[130:131] op_sel:[0,1,0] op_sel_hi:[1,1,0]
    v_pk_mul_f32 v[76:77], v[76:77], v[168:169]
    v_pk_mul_f32 v[78:79], v[78:79], v[170:171]
    v_exp_f32 v76, v76
    v_exp_f32 v77, v77
    v_exp_f32 v78, v78
    v_exp_f32 v79, v79
    v_pk_mul_f32 v[168:169], v[168:169], v[216:217]
    v_pk_mul_f32 v[170:171], v[170:171], v[218:219]
    v_pk_fma_f32 v[76:77], v[76:77], v[128:129], v[128:129] op_sel:[0,1,1] op_sel_hi:[1,1,1]
    v_pk_fma_f32 v[78:79], v[78:79], v[128:129], v[128:129] op_sel:[0,1,1] op_sel_hi:[1,1,1]
    v_rcp_f32 v76, v76
    v_rcp_f32 v77, v77
    v_rcp_f32 v78, v78
    v_rcp_f32 v79, v79
    v_pk_mul_f32 v[76:77], v[76:77], v[168:169]
    v_pk_mul_f32 v[78:79], v[78:79], v[170:171]
    v_cvt_pk_bf16_f32 v96, v76, v77
    v_cvt_pk_bf16_f32 v97, v78, v79
    v_pk_mul_f32 v[80:81], v[172:173], v[172:173]
    v_pk_mul_f32 v[82:83], v[174:175], v[174:175]
    v_pk_fma_f32 v[80:81], v[80:81], v[66:67], v[66:67] op_sel:[0,1,0] op_sel_hi:[1,1,0]
    v_pk_fma_f32 v[82:83], v[82:83], v[66:67], v[66:67] op_sel:[0,1,0] op_sel_hi:[1,1,0]
    v_pk_mul_f32 v[80:81], v[80:81], v[172:173]
    v_pk_mul_f32 v[82:83], v[82:83], v[174:175]
    v_exp_f32 v80, v80
    v_exp_f32 v81, v81
    v_exp_f32 v82, v82
    v_exp_f32 v83, v83
    v_pk_mul_f32 v[172:173], v[172:173], v[220:221]
    v_pk_mul_f32 v[174:175], v[174:175], v[222:223]
    v_pk_fma_f32 v[80:81], v[80:81], v[64:65], v[64:65] op_sel:[0,1,1] op_sel_hi:[1,1,1]
    v_pk_fma_f32 v[82:83], v[82:83], v[64:65], v[64:65] op_sel:[0,1,1] op_sel_hi:[1,1,1]
    v_rcp_f32 v80, v80
    v_rcp_f32 v81, v81
    v_rcp_f32 v82, v82
    v_rcp_f32 v83, v83
    v_pk_mul_f32 v[80:81], v[80:81], v[172:173]
    v_pk_mul_f32 v[82:83], v[82:83], v[174:175]
    v_cvt_pk_bf16_f32 v98, v80, v81
    v_cvt_pk_bf16_f32 v99, v82, v83
    v_pk_mul_f32 v[76:77], v[176:177], v[176:177]
    v_pk_mul_f32 v[78:79], v[178:179], v[178:179]
    v_permlane16_swap_b32 v96, v98
    v_permlane16_swap_b32 v97, v99
    buffer_store_dwordx4 v[96:99], v134, s[24:27], s51 offen offset:512 sc1
    v_pk_fma_f32 v[76:77], v[76:77], v[122:123], v[122:123] op_sel:[0,1,0] op_sel_hi:[1,1,0]
    v_pk_fma_f32 v[78:79], v[78:79], v[122:123], v[122:123] op_sel:[0,1,0] op_sel_hi:[1,1,0]
    v_pk_mul_f32 v[76:77], v[76:77], v[176:177]
    v_pk_mul_f32 v[78:79], v[78:79], v[178:179]
    v_exp_f32 v76, v76
    v_exp_f32 v77, v77
    v_exp_f32 v78, v78
    v_exp_f32 v79, v79
    v_pk_mul_f32 v[176:177], v[176:177], v[224:225]
    v_pk_mul_f32 v[178:179], v[178:179], v[226:227]
    v_pk_fma_f32 v[76:77], v[76:77], v[120:121], v[120:121] op_sel:[0,1,1] op_sel_hi:[1,1,1]
    v_pk_fma_f32 v[78:79], v[78:79], v[120:121], v[120:121] op_sel:[0,1,1] op_sel_hi:[1,1,1]
    v_rcp_f32 v76, v76
    v_rcp_f32 v77, v77
    v_rcp_f32 v78, v78
    v_rcp_f32 v79, v79
    v_pk_mul_f32 v[76:77], v[76:77], v[176:177]
    v_pk_mul_f32 v[78:79], v[78:79], v[178:179]
    v_cvt_pk_bf16_f32 v100, v76, v77
    v_cvt_pk_bf16_f32 v101, v78, v79
    v_pk_mul_f32 v[80:81], v[180:181], v[180:181]
    v_pk_mul_f32 v[82:83], v[182:183], v[182:183]
    v_pk_fma_f32 v[80:81], v[80:81], v[126:127], v[126:127] op_sel:[0,1,0] op_sel_hi:[1,1,0]
    v_pk_fma_f32 v[82:83], v[82:83], v[126:127], v[126:127] op_sel:[0,1,0] op_sel_hi:[1,1,0]
    v_pk_mul_f32 v[80:81], v[80:81], v[180:181]
    v_pk_mul_f32 v[82:83], v[82:83], v[182:183]
    v_exp_f32 v80, v80
    v_exp_f32 v81, v81
    v_exp_f32 v82, v82
    v_exp_f32 v83, v83
    v_pk_mul_f32 v[180:181], v[180:181], v[228:229]
    v_pk_mul_f32 v[182:183], v[182:183], v[230:231]
    v_pk_fma_f32 v[80:81], v[80:81], v[124:125], v[124:125] op_sel:[0,1,1] op_sel_hi:[1,1,1]
    v_pk_fma_f32 v[82:83], v[82:83], v[124:125], v[124:125] op_sel:[0,1,1] op_sel_hi:[1,1,1]
    v_rcp_f32 v80, v80
    v_rcp_f32 v81, v81
    v_rcp_f32 v82, v82
    v_rcp_f32 v83, v83
    v_pk_mul_f32 v[80:81], v[80:81], v[180:181]
    v_pk_mul_f32 v[82:83], v[82:83], v[182:183]
    v_cvt_pk_bf16_f32 v102, v80, v81
    v_cvt_pk_bf16_f32 v103, v82, v83
    v_pk_mul_f32 v[76:77], v[184:185], v[184:185]
    v_pk_mul_f32 v[78:79], v[186:187], v[186:187]
    v_permlane16_swap_b32 v100, v102
    v_permlane16_swap_b32 v101, v103
    buffer_store_dwordx4 v[100:103], v134, s[24:27], s52 offen offset:0 sc1
    v_pk_fma_f32 v[76:77], v[76:77], v[130:131], v[130:131] op_sel:[0,1,0] op_sel_hi:[1,1,0]
    v_pk_fma_f32 v[78:79], v[78:79], v[130:131], v[130:131] op_sel:[0,1,0] op_sel_hi:[1,1,0]
    v_pk_mul_f32 v[76:77], v[76:77], v[184:185]
    v_pk_mul_f32 v[78:79], v[78:79], v[186:187]
    v_exp_f32 v76, v76
    v_exp_f32 v77, v77
    v_exp_f32 v78, v78
    v_exp_f32 v79, v79
    v_pk_mul_f32 v[184:185], v[184:185], v[232:233]
    v_pk_mul_f32 v[186:187], v[186:187], v[234:235]
    v_pk_fma_f32 v[76:77], v[76:77], v[128:129], v[128:129] op_sel:[0,1,1] op_sel_hi:[1,1,1]
    v_pk_fma_f32 v[78:79], v[78:79], v[128:129], v[128:129] op_sel:[0,1,1] op_sel_hi:[1,1,1]
    v_rcp_f32 v76, v76
    v_rcp_f32 v77, v77
    v_rcp_f32 v78, v78
    v_rcp_f32 v79, v79
    v_pk_mul_f32 v[76:77], v[76:77], v[184:185]
    v_pk_mul_f32 v[78:79], v[78:79], v[186:187]
    v_cvt_pk_bf16_f32 v104, v76, v77
    v_cvt_pk_bf16_f32 v105, v78, v79
    v_pk_mul_f32 v[80:81], v[188:189], v[188:189]
    v_pk_mul_f32 v[82:83], v[190:191], v[190:191]
    v_pk_fma_f32 v[80:81], v[80:81], v[66:67], v[66:67] op_sel:[0,1,0] op_sel_hi:[1,1,0]
    v_pk_fma_f32 v[82:83], v[82:83], v[66:67], v[66:67] op_sel:[0,1,0] op_sel_hi:[1,1,0]
    v_pk_mul_f32 v[80:81], v[80:81], v[188:189]
    v_pk_mul_f32 v[82:83], v[82:83], v[190:191]
    v_exp_f32 v80, v80
    v_exp_f32 v81, v81
    v_exp_f32 v82, v82
    v_exp_f32 v83, v83
    v_pk_mul_f32 v[188:189], v[188:189], v[236:237]
    v_pk_mul_f32 v[190:191], v[190:191], v[238:239]
    v_pk_fma_f32 v[80:81], v[80:81], v[64:65], v[64:65] op_sel:[0,1,1] op_sel_hi:[1,1,1]
    v_pk_fma_f32 v[82:83], v[82:83], v[64:65], v[64:65] op_sel:[0,1,1] op_sel_hi:[1,1,1]
    v_rcp_f32 v80, v80
    v_rcp_f32 v81, v81
    v_rcp_f32 v82, v82
    v_rcp_f32 v83, v83
    v_pk_mul_f32 v[80:81], v[80:81], v[188:189]
    v_pk_mul_f32 v[82:83], v[82:83], v[190:191]
    v_cvt_pk_bf16_f32 v106, v80, v81
    v_cvt_pk_bf16_f32 v107, v82, v83
    s_nop 1
    v_permlane16_swap_b32 v104, v106
    v_permlane16_swap_b32 v105, v107
    buffer_store_dwordx4 v[104:107], v134, s[24:27], s52 offen offset:512 sc1
    v_pk_mul_f32 v[76:77], v[240:241], v[240:241]
    v_pk_mul_f32 v[78:79], v[242:243], v[242:243]
    v_pk_fma_f32 v[76:77], v[76:77], v[70:71], v[70:71] op_sel:[0,1,0] op_sel_hi:[1,1,0]
    v_pk_fma_f32 v[78:79], v[78:79], v[70:71], v[70:71] op_sel:[0,1,0] op_sel_hi:[1,1,0]
    v_pk_mul_f32 v[76:77], v[76:77], v[240:241]
    v_pk_mul_f32 v[78:79], v[78:79], v[242:243]
    v_exp_f32 v76, v76
    v_exp_f32 v77, v77
    v_exp_f32 v78, v78
    v_exp_f32 v79, v79
    v_pk_mul_f32 v[240:241], v[240:241], v[244:245]
    v_pk_mul_f32 v[242:243], v[242:243], v[246:247]
    v_pk_fma_f32 v[76:77], v[76:77], v[68:69], v[68:69] op_sel:[0,1,1] op_sel_hi:[1,1,1]
    v_pk_fma_f32 v[78:79], v[78:79], v[68:69], v[68:69] op_sel:[0,1,1] op_sel_hi:[1,1,1]
    v_rcp_f32 v76, v76
    v_rcp_f32 v77, v77
    v_rcp_f32 v78, v78
    v_rcp_f32 v79, v79
    v_pk_mul_f32 v[76:77], v[76:77], v[240:241]
    v_pk_mul_f32 v[78:79], v[78:79], v[242:243]
    v_cvt_pk_bf16_f32 v108, v76, v77
    v_cvt_pk_bf16_f32 v109, v78, v79
    v_pk_mul_f32 v[80:81], v[248:249], v[248:249]
    v_pk_mul_f32 v[82:83], v[250:251], v[250:251]
    v_pk_fma_f32 v[80:81], v[80:81], v[74:75], v[74:75] op_sel:[0,1,0] op_sel_hi:[1,1,0]
    v_pk_fma_f32 v[82:83], v[82:83], v[74:75], v[74:75] op_sel:[0,1,0] op_sel_hi:[1,1,0]
    v_pk_mul_f32 v[80:81], v[80:81], v[248:249]
    v_pk_mul_f32 v[82:83], v[82:83], v[250:251]
    v_exp_f32 v80, v80
    v_exp_f32 v81, v81
    v_exp_f32 v82, v82
    v_exp_f32 v83, v83
    v_pk_mul_f32 v[248:249], v[248:249], v[252:253]
    v_pk_mul_f32 v[250:251], v[250:251], v[254:255]
    v_pk_fma_f32 v[80:81], v[80:81], v[72:73], v[72:73] op_sel:[0,1,1] op_sel_hi:[1,1,1]
    v_pk_fma_f32 v[82:83], v[82:83], v[72:73], v[72:73] op_sel:[0,1,1] op_sel_hi:[1,1,1]
    v_rcp_f32 v80, v80
    v_rcp_f32 v81, v81
    v_rcp_f32 v82, v82
    v_rcp_f32 v83, v83
    v_pk_mul_f32 v[80:81], v[80:81], v[248:249]
    v_pk_mul_f32 v[82:83], v[82:83], v[250:251]
    v_cvt_pk_bf16_f32 v110, v80, v81
    v_cvt_pk_bf16_f32 v111, v82, v83
    s_nop 1
    v_permlane16_swap_b32 v108, v110
    v_permlane16_swap_b32 v109, v111
    buffer_store_dwordx4 v[108:111], v135, s[24:27], 0 offen sc1
    s_and_b32 s31, s2, 7
    s_lshr_b32 s32, s2, 3
    s_and_b32 s33, s31, 3
    s_lshl_b32 s33, s33, 2
    s_and_b32 s35, s32, 3
    s_add_u32 s33, s33, s35
    s_lshr_b32 s34, s32, 2
    s_lshr_b32 s29, s31, 2
    s_cmp_ge_u32 s30, 4
    s_cbranch_scc0 L_g12_notl
    s_sub_u32 s39, s30, 4
    s_lshl_b32 s35, s39, 16
    s_lshl_b32 s36, s33, 11
    s_add_u32 s35, s35, s36
    v_lshl_add_u32 v2, v14, 4, s35
    v_add_u32 v3, 30720, v2
    v_lshlrev_b32 v4, 1, v15
    v_xor_b32 v4, v4, v17
    v_xor_b32 v5, 8, v4
    s_lshl_b32 s35, s39, 15
    s_lshl_b32 s36, s34, 8
    s_add_u32 s35, s35, s36
    v_lshl_add_u32 v8, v15, 11, s35
    v_lshl_add_u32 v4, v4, 4, v8
    v_lshl_add_u32 v6, v5, 4, v8
    v_add_u32 v5, 7168, v4
    v_add_u32 v7, 21504, v6
    v_add_u32 v6, 14336, v6
    s_lshl_b32 s40, s39, 12
    s_add_u32 s41, s40, 16384
    s_mul_i32 s43, s29, 7340032
    s_mul_i32 s44, s29, 3670016
    s_add_u32 s12, s8, 0x01800000
    s_addc_u32 s13, s9, 0
    s_mov_b32 s14, 0x00e00000
    s_mov_b32 s15, 0x00020000
    s_mov_b32 s16, s10
    s_mov_b32 s17, s11
    s_mov_b32 s18, 0x00700000
    s_mov_b32 s19, 0x00020000
    s_add_u32 s14, s43, 7340032
    s_add_u32 s18, s44, 3670016
L_g12_notl:
    s_add_u32 s56, s8, 0x01750000
    s_addc_u32 s57, s9, 0
    s_mov_b32 s58, 0x00010000
    s_mov_b32 s59, 0x00020000
    s_setprio 0
    s_waitcnt vmcnt(0)
    s_barrier
    s_cmp_ge_u32 s30, 4
    s_cbranch_scc0 L_g2_cons
    s_cmp_eq_u32 s30, 4
    s_cbranch_scc0 L_g12_w
    v_mov_b32 v9, s72
    v_lshlrev_b32 v10, 7, v14
    s_mov_b64 exec, 1
    buffer_store_dword v9, v10, s[56:59], s28 offen sc1
    s_mov_b64 exec, -1
L_g12_w:
    s_add_u32 m0, s41, 0
    s_nop 0
    buffer_load_dwordx4 v4, s[16:19], s44 offen offset:0 lds
    buffer_load_dwordx4 v5, s[16:19], s44 offen offset:1024 lds
    buffer_load_dwordx4 v6, s[16:19], s44 offen offset:2048 lds
    buffer_load_dwordx4 v7, s[16:19], s44 offen offset:3072 lds
    s_add_u32 s44, s44, 131072
    s_add_u32 m0, s41, 32768
    s_nop 0
    buffer_load_dwordx4 v4, s[16:19], s44 offen offset:0 lds
    buffer_load_dwordx4 v5, s[16:19], s44 offen offset:1024 lds
    buffer_load_dwordx4 v6, s[16:19], s44 offen offset:2048 lds
    buffer_load_dwordx4 v7, s[16:19], s44 offen offset:3072 lds
    s_add_u32 s44, s44, 131072
    s_add_u32 m0, s41, 65536
    s_nop 0
    buffer_load_dwordx4 v4, s[16:19], s44 offen offset:0 lds
    buffer_load_dwordx4 v5, s[16:19], s44 offen offset:1024 lds
    buffer_load_dwordx4 v6, s[16:19], s44 offen offset:2048 lds
    buffer_load_dwordx4 v7, s[16:19], s44 offen offset:3072 lds
    s_add_u32 s44, s44, 131072
    s_add_u32 m0, s41, 98304
    s_nop 0
    buffer_load_dwordx4 v4, s[16:19], s44 offen offset:0 lds
    buffer_load_dwordx4 v5, s[16:19], s44 offen offset:1024 lds
    buffer_load_dwordx4 v6, s[16:19], s44 offen offset:2048 lds
    buffer_load_dwordx4 v7, s[16:19], s44 offen offset:3072 lds
    s_add_u32 s44, s44, 131072
    s_cmp_eq_u32 s30, 4
    s_cbranch_scc0 L_g12_go
    s_mov_b64 exec, 1
    s_and_b32 s35, s33, 14
    s_lshl_b32 s35, s35, 11
    s_add_u32 s35, s35, 32768
    s_mov_b32 s48, 0
    s_mov_b32 exec_lo, -1
L_g12_poll:
    s_sleep 2
    buffer_load_dword v11, v10, s[56:59], s35 offen sc1
    s_add_u32 s48, s48, 1
    s_waitcnt vmcnt(0)
    v_cmp_ne_u32 vcc, s72, v11
    s_cmp_ge_u32 s48, 0x80000
    s_cbranch_vccz L_g12_seen
    s_cbranch_scc0 L_g12_poll
L_g12_seen:
    s_mov_b64 exec, -1
L_g12_go:
    s_barrier
    s_add_u32 m0, s40, 0
    s_nop 0
    buffer_load_dwordx4 v2, s[12:15], s43 offen sc1 lds
    buffer_load_dwordx4 v2, s[12:15], s43 offen offset:1024 sc1 lds
    buffer_load_dwordx4 v3, s[12:15], s43 offen offset:2048 sc1 lds
    buffer_load_dwordx4 v3, s[12:15], s43 offen offset:3072 sc1 lds
    s_add_u32 s43, s43, 262144
    s_add_u32 m0, s40, 32768
    s_nop 0
    buffer_load_dwordx4 v2, s[12:15], s43 offen sc1 lds
    buffer_load_dwordx4 v2, s[12:15], s43 offen offset:1024 sc1 lds
    buffer_load_dwordx4 v3, s[12:15], s43 offen offset:2048 sc1 lds
    buffer_load_dwordx4 v3, s[12:15], s43 offen offset:3072 sc1 lds
    s_add_u32 s43, s43, 262144
    s_add_u32 m0, s40, 65536
    s_nop 0
    buffer_load_dwordx4 v2, s[12:15], s43 offen sc1 lds
    buffer_load_dwordx4 v2, s[12:15], s43 offen offset:1024 sc1 lds
    buffer_load_dwordx4 v3, s[12:15], s43 offen offset:2048 sc1 lds
    buffer_load_dwordx4 v3, s[12:15], s43 offen offset:3072 sc1 lds
    s_add_u32 s43, s43, 262144
    s_waitcnt vmcnt(8)
    s_barrier
    s_add_u32 m0, s40, 98304
    s_nop 0
    buffer_load_dwordx4 v2, s[12:15], s43 offen sc1 lds
    buffer_load_dwordx4 v2, s[12:15], s43 offen offset:1024 sc1 lds
    buffer_load_dwordx4 v3, s[12:15], s43 offen offset:2048 sc1 lds
    buffer_load_dwordx4 v3, s[12:15], s43 offen offset:3072 sc1 lds
    s_add_u32 s43, s43, 262144
    s_waitcnt vmcnt(8)
    s_barrier
    s_add_u32 m0, s40, 0
    s_nop 0
    buffer_load_dwordx4 v2, s[12:15], s43 offen sc1 lds
    buffer_load_dwordx4 v2, s[12:15], s43 offen offset:1024 sc1 lds
    buffer_load_dwordx4 v3, s[12:15], s43 offen offset:2048 sc1 lds
    buffer_load_dwordx4 v3, s[12:15], s43 offen offset:3072 sc1 lds
    s_add_u32 s43, s43, 262144
    s_add_u32 m0, s41, 0
    s_nop 0
    buffer_load_dwordx4 v4, s[16:19], s44 offen offset:0 lds
    buffer_load_dwordx4 v5, s[16:19], s44 offen offset:1024 lds
    buffer_load_dwordx4 v6, s[16:19], s44 offen offset:2048 lds
    buffer_load_dwordx4 v7, s[16:19], s44 offen offset:3072 lds
    s_add_u32 s44, s44, 131072
    s_waitcnt vmcnt(12)
    s_barrier
    s_add_u32 m0, s40, 32768
    s_nop 0
    buffer_load_dwordx4 v2, s[12:15], s43 offen sc1 lds
    buffer_load_dwordx4 v2, s[12:15], s43 offen offset:1024 sc1 lds
    buffer_load_dwordx4 v3, s[12:15], s43 offen offset:2048 sc1 lds
    buffer_load_dwordx4 v3, s[12:15], s43 offen offset:3072 sc1 lds
    s_add_u32 s43, s43, 262144
    s_add_u32 m0, s41, 32768
    s_nop 0
    buffer_load_dwordx4 v4, s[16:19], s44 offen offset:0 lds
    buffer_load_dwordx4 v5, s[16:19], s44 offen offset:1024 lds
    buffer_load_dwordx4 v6, s[16:19], s44 offen offset:2048 lds
    buffer_load_dwordx4 v7, s[16:19], s44 offen offset:3072 lds
    s_add_u32 s44, s44, 131072
    s_waitcnt vmcnt(16)
    s_barrier
    s_add_u32 m0, s40, 65536
    s_nop 0
    buffer_load_dwordx4 v2, s[12:15], s43 offen sc1 lds
    buffer_load_dwordx4 v2, s[12:15], s43 offen offset:1024 sc1 lds
    buffer_load_dwordx4 v3, s[12:15], s43 offen offset:2048 sc1 lds
    buffer_load_dwordx4 v3, s[12:15], s43 offen offset:3072 sc1 lds
    s_add_u32 s43, s43, 262144
    s_add_u32 m0, s41, 65536
    s_nop 0
    buffer_load_dwordx4 v4, s[16:19], s44 offen offset:0 lds
    buffer_load_dwordx4 v5, s[16:19], s44 offen offset:1024 lds
    buffer_load_dwordx4 v6, s[16:19], s44 offen offset:2048 lds
    buffer_load_dwordx4 v7, s[16:19], s44 offen offset:3072 lds
    s_add_u32 s44, s44, 131072
    s_waitcnt vmcnt(16)
    s_barrier
    s_add_u32 m0, s40, 98304
    s_nop 0
    buffer_load_dwordx4 v2, s[12:15], s43 offen sc1 lds
    buffer_load_dwordx4 v2, s[12:15], s43 offen offset:1024 sc1 lds
    buffer_load_dwordx4 v3, s[12:15], s43 offen offset:2048 sc1 lds
    buffer_load_dwordx4 v3, s[12:15], s43 offen offset:3072 sc1 lds
    s_add_u32 s43, s43, 262144
    s_add_u32 m0, s41, 98304
    s_nop 0
    buffer_load_dwordx4 v4, s[16:19], s44 offen offset:0 lds
    buffer_load_dwordx4 v5, s[16:19], s44 offen offset:1024 lds
    buffer_load_dwordx4 v6, s[16:19], s44 offen offset:2048 lds
    buffer_load_dwordx4 v7, s[16:19], s44 offen offset:3072 lds
    s_add_u32 s44, s44, 131072
    s_waitcnt vmcnt(16)
    s_barrier
    s_add_u32 m0, s40, 0
    s_nop 0
    buffer_load_dwordx4 v2, s[12:15], s43 offen sc1 lds
    buffer_load_dwordx4 v2, s[12:15], s43 offen offset:1024 sc1 lds
    buffer_load_dwordx4 v3, s[12:15], s43 offen offset:2048 sc1 lds
    buffer_load_dwordx4 v3, s[12:15], s43 offen offset:3072 sc1 lds
    s_add_u32 s43, s43, 262144
    s_add_u32 m0, s41, 0
    s_nop 0
    buffer_load_dwordx4 v4, s[16:19], s44 offen offset:0 lds
    buffer_load_dwordx4 v5, s[16:19], s44 offen offset:1024 lds
    buffer_load_dwordx4 v6, s[16:19], s44 offen offset:2048 lds
    buffer_load_dwordx4 v7, s[16:19], s44 offen offset:3072 lds
    s_add_u32 s44, s44, 131072
    s_waitcnt vmcnt(16)
    s_barrier
    s_add_u32 m0, s40, 32768
    s_nop 0
    buffer_load_dwordx4 v2, s[12:15], s43 offen sc1 lds
    buffer_load_dwordx4 v2, s[12:15], s43 offen offset:1024 sc1 lds
    buffer_load_dwordx4 v3, s[12:15], s43 offen offset:2048 sc1 lds
    buffer_load_dwordx4 v3, s[12:15], s43 offen offset:3072 sc1 lds
    s_add_u32 s43, s43, 262144
    s_add_u32 m0, s41, 32768
    s_nop 0
    buffer_load_dwordx4 v4, s[16:19], s44 offen offset:0 lds
    buffer_load_dwordx4 v5, s[16:19], s44 offen offset:1024 lds
    buffer_load_dwordx4 v6, s[16:19], s44 offen offset:2048 lds
    buffer_load_dwordx4 v7, s[16:19], s44 offen offset:3072 lds
    s_add_u32 s44, s44, 131072
    s_waitcnt vmcnt(16)
    s_barrier
    s_add_u32 m0, s40, 65536
    s_nop 0
    buffer_load_dwordx4 v2, s[12:15], s43 offen sc1 lds
    buffer_load_dwordx4 v2, s[12:15], s43 offen offset:1024 sc1 lds
    buffer_load_dwordx4 v3, s[12:15], s43 offen offset:2048 sc1 lds
    buffer_load_dwordx4 v3, s[12:15], s43 offen offset:3072 sc1 lds
    s_add_u32 s43, s43, 262144
    s_add_u32 m0, s41, 65536
    s_nop 0
    buffer_load_dwordx4 v4, s[16:19], s44 offen offset:0 lds
    buffer_load_dwordx4 v5, s[16:19], s44 offen offset:1024 lds
    buffer_load_dwordx4 v6, s[16:19], s44 offen offset:2048 lds
    buffer_load_dwordx4 v7, s[16:19], s44 offen offset:3072 lds
    s_add_u32 s44, s44, 131072
    s_waitcnt vmcnt(16)
    s_barrier
    s_add_u32 m0, s40, 98304
    s_nop 0
    buffer_load_dwordx4 v2, s[12:15], s43 offen sc1 lds
    buffer_load_dwordx4 v2, s[12:15], s43 offen offset:1024 sc1 lds
    buffer_load_dwordx4 v3, s[12:15], s43 offen offset:2048 sc1 lds
    buffer_load_dwordx4 v3, s[12:15], s43 offen offset:3072 sc1 lds
    s_add_u32 s43, s43, 262144
    s_add_u32 m0, s41, 98304
    s_nop 0
    buffer_load_dwordx4 v4, s[16:19], s44 offen offset:0 lds
    buffer_load_dwordx4 v5, s[16:19], s44 offen offset:1024 lds
    buffer_load_dwordx4 v6, s[16:19], s44 offen offset:2048 lds
    buffer_load_dwordx4 v7, s[16:19], s44 offen offset:3072 lds
    s_add_u32 s44, s44, 131072
    s_waitcnt vmcnt(16)
    s_barrier
    s_add_u32 m0, s40, 0
    s_nop 0
    buffer_load_dwordx4 v2, s[12:15], s43 offen sc1 lds
    buffer_load_dwordx4 v2, s[12:15], s43 offen offset:1024 sc1 lds
    buffer_load_dwordx4 v3, s[12:15], s43 offen offset:2048 sc1 lds
    buffer_load_dwordx4 v3, s[12:15], s43 offen offset:3072 sc1 lds
    s_add_u32 s43, s43, 262144
    s_add_u32 m0, s41, 0
    s_nop 0
    buffer_load_dwordx4 v4, s[16:19], s44 offen offset:0 lds
    buffer_load_dwordx4 v5, s[16:19], s44 offen offset:1024 lds
    buffer_load_dwordx4 v6, s[16:19], s44 offen offset:2048 lds
    buffer_load_dwordx4 v7, s[16:19], s44 offen offset:3072 lds
    s_add_u32 s44, s44, 131072
    s_waitcnt vmcnt(16)
    s_barrier
    s_add_u32 m0, s40, 32768
    s_nop 0
    buffer_load_dwordx4 v2, s[12:15], s43 offen sc1 lds
    buffer_load_dwordx4 v2, s[12:15], s43 offen offset:1024 sc1 lds
    buffer_load_dwordx4 v3, s[12:15], s43 offen offset:2048 sc1 lds
    buffer_load_dwordx4 v3, s[12:15], s43 offen offset:3072 sc1 lds
    s_add_u32 s43, s43, 262144
    s_add_u32 m0, s41, 32768
    s_nop 0
    buffer_load_dwordx4 v4, s[16:19], s44 offen offset:0 lds
    buffer_load_dwordx4 v5, s[16:19], s44 offen offset:1024 lds
    buffer_load_dwordx4 v6, s[16:19], s44 offen offset:2048 lds
    buffer_load_dwordx4 v7, s[16:19], s44 offen offset:3072 lds
    s_add_u32 s44, s44, 131072
    s_waitcnt vmcnt(16)
    s_barrier
    s_add_u32 m0, s40, 65536
    s_nop 0
    buffer_load_dwordx4 v2, s[12:15], s43 offen sc1 lds
    buffer_load_dwordx4 v2, s[12:15], s43 offen offset:1024 sc1 lds
    buffer_load_dwordx4 v3, s[12:15], s43 offen offset:2048 sc1 lds
    buffer_load_dwordx4 v3, s[12:15], s43 offen offset:3072 sc1 lds
    s_add_u32 s43, s43, 262144
    s_add_u32 m0, s41, 65536
    s_nop 0
    buffer_load_dwordx4 v4, s[16:19], s44 offen offset:0 lds
    buffer_load_dwordx4 v5, s[16:19], s44 offen offset:1024 lds
    buffer_load_dwordx4 v6, s[16:19], s44 offen offset:2048 lds
    buffer_load_dwordx4 v7, s[16:19], s44 offen offset:3072 lds
    s_add_u32 s44, s44, 131072
    s_waitcnt vmcnt(16)
    s_barrier
    s_add_u32 m0, s40, 98304
    s_nop 0
    buffer_load_dwordx4 v2, s[12:15], s43 offen sc1 lds
    buffer_load_dwordx4 v2, s[12:15], s43 offen offset:1024 sc1 lds
    buffer_load_dwordx4 v3, s[12:15], s43 offen offset:2048 sc1 lds
    buffer_load_dwordx4 v3, s[12:15], s43 offen offset:3072 sc1 lds
    s_add_u32 s43, s43, 262144
    s_add_u32 m0, s41, 98304
    s_nop 0
    buffer_load_dwordx4 v4, s[16:19], s44 offen offset:0 lds
    buffer_load_dwordx4 v5, s[16:19], s44 offen offset:1024 lds
    buffer_load_dwordx4 v6, s[16:19], s44 offen offset:2048 lds
    buffer_load_dwordx4 v7, s[16:19], s44 offen offset:3072 lds
    s_add_u32 s44, s44, 131072
    s_waitcnt vmcnt(16)
    s_barrier
    s_add_u32 m0, s40, 0
    s_nop 0
    buffer_load_dwordx4 v2, s[12:15], s43 offen sc1 lds
    buffer_load_dwordx4 v2, s[12:15], s43 offen offset:1024 sc1 lds
    buffer_load_dwordx4 v3, s[12:15], s43 offen offset:2048 sc1 lds
    buffer_load_dwordx4 v3, s[12:15], s43 offen offset:3072 sc1 lds
    s_add_u32 s43, s43, 262144
    s_add_u32 m0, s41, 0
    s_nop 0
    buffer_load_dwordx4 v4, s[16:19], s44 offen offset:0 lds
    buffer_load_dwordx4 v5, s[16:19], s44 offen offset:1024 lds
    buffer_load_dwordx4 v6, s[16:19], s44 offen offset:2048 lds
    buffer_load_dwordx4 v7, s[16:19], s44 offen offset:3072 lds
    s_add_u32 s44, s44, 131072
    s_waitcnt vmcnt(16)
    s_barrier
    s_add_u32 m0, s40, 32768
    s_nop 0
    buffer_load_dwordx4 v2, s[12:15], s43 offen sc1 lds
    buffer_load_dwordx4 v2, s[12:15], s43 offen offset:1024 sc1 lds
    buffer_load_dwordx4 v3, s[12:15], s43 offen offset:2048 sc1 lds
    buffer_load_dwordx4 v3, s[12:15], s43 offen offset:3072 sc1 lds
    s_add_u32 s43, s43, 262144
    s_add_u32 m0, s41, 32768
    s_nop 0
    buffer_load_dwordx4 v4, s[16:19], s44 offen offset:0 lds
    buffer_load_dwordx4 v5, s[16:19], s44 offen offset:1024 lds
    buffer_load_dwordx4 v6, s[16:19], s44 offen offset:2048 lds
    buffer_load_dwordx4 v7, s[16:19], s44 offen offset:3072 lds
    s_add_u32 s44, s44, 131072
    s_waitcnt vmcnt(16)
    s_barrier
    s_add_u32 m0, s40, 65536
    s_nop 0
    buffer_load_dwordx4 v2, s[12:15], s43 offen sc1 lds
    buffer_load_dwordx4 v2, s[12:15], s43 offen offset:1024 sc1 lds
    buffer_load_dwordx4 v3, s[12:15], s43 offen offset:2048 sc1 lds
    buffer_load_dwordx4 v3, s[12:15], s43 offen offset:3072 sc1 lds
    s_add_u32 s43, s43, 262144
    s_add_u32 m0, s41, 65536
    s_nop 0
    buffer_load_dwordx4 v4, s[16:19], s44 offen offset:0 lds
    buffer_load_dwordx4 v5, s[16:19], s44 offen offset:1024 lds
    buffer_load_dwordx4 v6, s[16:19], s44 offen offset:2048 lds
    buffer_load_dwordx4 v7, s[16:19], s44 offen offset:3072 lds
    s_add_u32 s44, s44, 131072
    s_waitcnt vmcnt(16)
    s_barrier
    s_add_u32 m0, s40, 98304
    s_nop 0
    buffer_load_dwordx4 v2, s[12:15], s43 offen sc1 lds
    buffer_load_dwordx4 v2, s[12:15], s43 offen offset:1024 sc1 lds
    buffer_load_dwordx4 v3, s[12:15], s43 offen offset:2048 sc1 lds
    buffer_load_dwordx4 v3, s[12:15], s43 offen offset:3072 sc1 lds
    s_add_u32 s43, s43, 262144
    s_add_u32 m0, s41, 98304
    s_nop 0
    buffer_load_dwordx4 v4, s[16:19], s44 offen offset:0 lds
    buffer_load_dwordx4 v5, s[16:19], s44 offen offset:1024 lds
    buffer_load_dwordx4 v6, s[16:19], s44 offen offset:2048 lds
    buffer_load_dwordx4 v7, s[16:19], s44 offen offset:3072 lds
    s_add_u32 s44, s44, 131072
    s_waitcnt vmcnt(16)
    s_barrier
    s_add_u32 m0, s40, 0
    s_nop 0
    buffer_load_dwordx4 v2, s[12:15], s43 offen sc1 lds
    buffer_load_dwordx4 v2, s[12:15], s43 offen offset:1024 sc1 lds
    buffer_load_dwordx4 v3, s[12:15], s43 offen offset:2048 sc1 lds
    buffer_load_dwordx4 v3, s[12:15], s43 offen offset:3072 sc1 lds
    s_add_u32 s43, s43, 262144
    s_add_u32 m0, s41, 0
    s_nop 0
    buffer_load_dwordx4 v4, s[16:19], s44 offen offset:0 lds
    buffer_load_dwordx4 v5, s[16:19], s44 offen offset:1024 lds
    buffer_load_dwordx4 v6, s[16:19], s44 offen offset:2048 lds
    buffer_load_dwordx4 v7, s[16:19], s44 offen offset:3072 lds
    s_add_u32 s44, s44, 131072
    s_waitcnt vmcnt(16)
    s_barrier
    s_add_u32 m0, s40, 32768
    s_nop 0
    buffer_load_dwordx4 v2, s[12:15], s43 offen sc1 lds
    buffer_load_dwordx4 v2, s[12:15], s43 offen offset:1024 sc1 lds
    buffer_load_dwordx4 v3, s[12:15], s43 offen offset:2048 sc1 lds
    buffer_load_dwordx4 v3, s[12:15], s43 offen offset:3072 sc1 lds
    s_add_u32 s43, s43, 262144
    s_add_u32 m0, s41, 32768
    s_nop 0
    buffer_load_dwordx4 v4, s[16:19], s44 offen offset:0 lds
    buffer_load_dwordx4 v5, s[16:19], s44 offen offset:1024 lds
    buffer_load_dwordx4 v6, s[16:19], s44 offen offset:2048 lds
    buffer_load_dwordx4 v7, s[16:19], s44 offen offset:3072 lds
    s_add_u32 s44, s44, 131072
    s_waitcnt vmcnt(16)
    s_barrier
    s_add_u32 m0, s40, 65536
    s_nop 0
    buffer_load_dwordx4 v2, s[12:15], s43 offen sc1 lds
    buffer_load_dwordx4 v2, s[12:15], s43 offen offset:1024 sc1 lds
    buffer_load_dwordx4 v3, s[12:15], s43 offen offset:2048 sc1 lds
    buffer_load_dwordx4 v3, s[12:15], s43 offen offset:3072 sc1 lds
    s_add_u32 s43, s43, 262144
    s_add_u32 m0, s41, 65536
    s_nop 0
    buffer_load_dwordx4 v4, s[16:19], s44 offen offset:0 lds
    buffer_load_dwordx4 v5, s[16:19], s44 offen offset:1024 lds
    buffer_load_dwordx4 v6, s[16:19], s44 offen offset:2048 lds
    buffer_load_dwordx4 v7, s[16:19], s44 offen offset:3072 lds
    s_add_u32 s44, s44, 131072
    s_waitcnt vmcnt(16)
    s_barrier
    s_add_u32 m0, s40, 98304
    s_nop 0
    buffer_load_dwordx4 v2, s[12:15], s43 offen sc1 lds
    buffer_load_dwordx4 v2, s[12:15], s43 offen offset:1024 sc1 lds
    buffer_load_dwordx4 v3, s[12:15], s43 offen offset:2048 sc1 lds
    buffer_load_dwordx4 v3, s[12:15], s43 offen offset:3072 sc1 lds
    s_add_u32 s43, s43, 262144
    s_add_u32 m0, s41, 98304
    s_nop 0
    buffer_load_dwordx4 v4, s[16:19], s44 offen offset:0 lds
    buffer_load_dwordx4 v5, s[16:19], s44 offen offset:1024 lds
    buffer_load_dwordx4 v6, s[16:19], s44 offen offset:2048 lds
    buffer_load_dwordx4 v7, s[16:19], s44 offen offset:3072 lds
    s_add_u32 s44, s44, 131072
    s_waitcnt vmcnt(16)
    s_barrier
    s_add_u32 m0, s40, 0
    s_nop 0
    buffer_load_dwordx4 v2, s[12:15], s43 offen sc1 lds
    buffer_load_dwordx4 v2, s[12:15], s43 offen offset:1024 sc1 lds
    buffer_load_dwordx4 v3, s[12:15], s43 offen offset:2048 sc1 lds
    buffer_load_dwordx4 v3, s[12:15], s43 offen offset:3072 sc1 lds
    s_add_u32 s43, s43, 262144
    s_add_u32 m0, s41, 0
    s_nop 0
    buffer_load_dwordx4 v4, s[16:19], s44 offen offset:0 lds
    buffer_load_dwordx4 v5, s[16:19], s44 offen offset:1024 lds
    buffer_load_dwordx4 v6, s[16:19], s44 offen offset:2048 lds
    buffer_load_dwordx4 v7, s[16:19], s44 offen offset:3072 lds
    s_add_u32 s44, s44, 131072
    s_waitcnt vmcnt(16)
    s_barrier
    s_add_u32 m0, s40, 32768
    s_nop 0
    buffer_load_dwordx4 v2, s[12:15], s43 offen sc1 lds
    buffer_load_dwordx4 v2, s[12:15], s43 offen offset:1024 sc1 lds
    buffer_load_dwordx4 v3, s[12:15], s43 offen offset:2048 sc1 lds
    buffer_load_dwordx4 v3, s[12:15], s43 offen offset:3072 sc1 lds
    s_add_u32 s43, s43, 262144
    s_add_u32 m0, s41, 32768
    s_nop 0
    buffer_load_dwordx4 v4, s[16:19], s44 offen offset:0 lds
    buffer_load_dwordx4 v5, s[16:19], s44 offen offset:1024 lds
    buffer_load_dwordx4 v6, s[16:19], s44 offen offset:2048 lds
    buffer_load_dwordx4 v7, s[16:19], s44 offen offset:3072 lds
    s_add_u32 s44, s44, 131072
    s_waitcnt vmcnt(16)
    s_barrier
    s_add_u32 m0, s40, 65536
    s_nop 0
    buffer_load_dwordx4 v2, s[12:15], s43 offen sc1 lds
    buffer_load_dwordx4 v2, s[12:15], s43 offen offset:1024 sc1 lds
    buffer_load_dwordx4 v3, s[12:15], s43 offen offset:2048 sc1 lds
    buffer_load_dwordx4 v3, s[12:15], s43 offen offset:3072 sc1 lds
    s_add_u32 s43, s43, 262144
    s_add_u32 m0, s41, 65536
    s_nop 0
    buffer_load_dwordx4 v4, s[16:19], s44 offen offset:0 lds
    buffer_load_dwordx4 v5, s[16:19], s44 offen offset:1024 lds
    buffer_load_dwordx4 v6, s[16:19], s44 offen offset:2048 lds
    buffer_load_dwordx4 v7, s[16:19], s44 offen offset:3072 lds
    s_add_u32 s44, s44, 131072
    s_waitcnt vmcnt(16)
    s_barrier
    s_add_u32 m0, s40, 98304
    s_nop 0
    buffer_load_dwordx4 v2, s[12:15], s43 offen sc1 lds
    buffer_load_dwordx4 v2, s[12:15], s43 offen offset:1024 sc1 lds
    buffer_load_dwordx4 v3, s[12:15], s43 offen offset:2048 sc1 lds
    buffer_load_dwordx4 v3, s[12:15], s43 offen offset:3072 sc1 lds
    s_add_u32 s43, s43, 262144
    s_add_u32 m0, s41, 98304
    s_nop 0
    buffer_load_dwordx4 v4, s[16:19], s44 offen offset:0 lds
    buffer_load_dwordx4 v5, s[16:19], s44 offen offset:1024 lds
    buffer_load_dwordx4 v6, s[16:19], s44 offen offset:2048 lds
    buffer_load_dwordx4 v7, s[16:19], s44 offen offset:3072 lds
    s_add_u32 s44, s44, 131072
    s_waitcnt vmcnt(16)
    s_barrier
    s_waitcnt vmcnt(8)
    s_barrier
    s_waitcnt vmcnt(0)
    s_barrier
    s_endpgm
L_g2_cons:
    s_lshr_b32 s38, s30, 1
    s_and_b32 s39, s30, 1
    v_lshlrev_b32 v18, 11, v15
    v_lshl_add_u32 v18, v17, 4, v18
    s_lshl_b32 s35, s38, 10
    s_lshl_b32 s36, s29, 9
    s_add_u32 s37, s35, s36
    v_add_u32 v2, s37, v18
    s_xor_b32 s36, s36, 512
    s_add_u32 s37, s35, s36
    v_add_u32 v3, s37, v18
    v_add_u32 v4, 65536, v2
    v_add_u32 v5, 65536, v3
    v_lshrrev_b32 v18, 2, v17
    v_lshl_add_u32 v19, v15, 3, v18
    v_lshlrev_b32 v19, 8, v19
    v_and_b32 v20, 3, v17
    v_lshl_add_u32 v19, v20, 3, v19
    v_add_u32 v19, 16384, v19
    v_and_b32 v20, 1, v15
    v_lshl_add_u32 v20, v20, 2, v18
    s_lshl_b32 s35, s39, 2
    s_add_u32 s36, s35, 0
    v_xor_b32 v21, s36, v20
    v_lshl_add_u32 v6, v21, 5, v19
    v_add_u32 v10, 65536, v6
    s_add_u32 s36, s35, 1
    v_xor_b32 v21, s36, v20
    v_lshl_add_u32 v7, v21, 5, v19
    v_add_u32 v11, 65536, v7
    s_add_u32 s36, s35, 2
    v_xor_b32 v21, s36, v20
    v_lshl_add_u32 v8, v21, 5, v19
    v_add_u32 v12, 65536, v8
    s_add_u32 s36, s35, 3
    v_xor_b32 v21, s36, v20
    v_lshl_add_u32 v9, v21, 5, v19
    v_add_u32 v13, 65536, v9
    v_and_b32 v18, 1, v15
    v_lshlrev_b32 v18, 1, v18
    v_lshrrev_b32 v19, 1, v15
    s_lshl_b32 s35, s34, 4
    s_lshl_b32 s36, s39, 3
    s_add_u32 s35, s35, s36
    v_add3_u32 v18, v18, v19, s35
    s_lshl_b32 s35, s33, 7
    s_lshl_b32 s36, s38, 6
    s_add_u32 s35, s35, s36
    s_lshl_b32 s36, s29, 5
    s_add_u32 s35, s35, s36
    v_add_u32 v19, s35, v17
    s_lshl_b32 s35, s34, 5
    s_lshl_b32 s36, s39, 4
    s_add_u32 s35, s35, s36
    v_add_u32 v20, s35, v15
    v_lshlrev_b32 v20, 14, v20
    v_lshl_add_u32 v20, v19, 3, v20
    s_mov_b32 s64, 0
    s_mov_b32 s65, 65536
    s_mov_b32 s66, 131072
    s_mov_b32 s67, 196608
    v_lshlrev_b32 v21, 11, v19
    v_lshl_add_u32 v21, v18, 4, v21
    v_lshlrev_b32 v22, 4, v14
    s_lshl_b32 s35, s33, 3
    s_add_u32 s35, s35, s34
    s_lshl_b32 s35, s35, 3
    s_add_u32 s35, s35, s30
    s_lshl_b32 s36, s29, 2
    s_add_u32 s50, s35, s36
    s_xor_b32 s51, s50, 4
    s_mov_b32 s49, 131072
    s_add_u32 s20, s8, 0x00c00000
    s_addc_u32 s21, s9, 0
    s_mov_b32 s22, 0x00400000
    s_mov_b32 s23, 0x00020000
    s_mov_b32 s24, s74
    s_mov_b32 s25, s75
    s_mov_b32 s26, 0x00400000
    s_mov_b32 s27, 0x00020000
    s_add_u32 s52, s8, 0x02800000
    s_addc_u32 s53, s9, 0
    s_mov_b32 s54, 0x00400000
    s_mov_b32 s55, 0x00020000
    s_mov_b32 s46, 0
    s_barrier
    s_barrier
    ds_read_b128 v[96:99], v2 offset:0
    ds_read_b64_tr_b16 v[112:113], v6 offset:0
    ds_read_b64_tr_b16 v[114:115], v6 offset:1024
    ds_read_b128 v[128:131], v2 offset:8192
    ds_read_b64_tr_b16 v[144:145], v6 offset:8192
    ds_read_b64_tr_b16 v[146:147], v6 offset:9216
    ds_read_b128 v[100:103], v2 offset:256
    ds_read_b64_tr_b16 v[116:117], v7 offset:0
    ds_read_b64_tr_b16 v[118:119], v7 offset:1024
    ds_read_b128 v[132:135], v2 offset:8448
    ds_read_b64_tr_b16 v[148:149], v7 offset:8192
    ds_read_b64_tr_b16 v[150:151], v7 offset:9216
    ds_read_b128 v[104:107], v3 offset:0
    ds_read_b64_tr_b16 v[120:121], v8 offset:0
    ds_read_b64_tr_b16 v[122:123], v8 offset:1024
    ds_read_b128 v[136:139], v3 offset:8192
    ds_read_b64_tr_b16 v[152:153], v8 offset:8192
    ds_read_b64_tr_b16 v[154:155], v8 offset:9216
    ds_read_b128 v[108:111], v3 offset:256
    ds_read_b64_tr_b16 v[124:125], v9 offset:0
    ds_read_b64_tr_b16 v[126:127], v9 offset:1024
    ds_read_b128 v[140:143], v3 offset:8448
    ds_read_b64_tr_b16 v[156:157], v9 offset:8192
    ds_read_b64_tr_b16 v[158:159], v9 offset:9216
    s_waitcnt lgkmcnt(0)
    s_barrier
    v_mfma_f32_16x16x32_bf16 v[32:35], v[112:115], v[96:99], 0
    ds_read_b128 v[160:163], v2 offset:32768
    v_mfma_f32_16x16x32_bf16 v[32:35], v[144:147], v[128:131], v[32:35]
    ds_read_b64_tr_b16 v[176:177], v6 offset:32768
    v_mfma_f32_16x16x32_bf16 v[36:39], v[116:119], v[96:99], 0
    ds_read_b64_tr_b16 v[178:179], v6 offset:33792
    v_mfma_f32_16x16x32_bf16 v[36:39], v[148:151], v[128:131], v[36:39]
    ds_read_b128 v[192:195], v2 offset:40960
    v_mfma_f32_16x16x32_bf16 v[40:43], v[120:123], v[96:99], 0
    ds_read_b64_tr_b16 v[208:209], v6 offset:40960
    v_mfma_f32_16x16x32_bf16 v[40:43], v[152:155], v[128:131], v[40:43]
    ds_read_b64_tr_b16 v[210:211], v6 offset:41984
    v_mfma_f32_16x16x32_bf16 v[44:47], v[124:127], v[96:99], 0
    ds_read_b128 v[164:167], v2 offset:33024
    v_mfma_f32_16x16x32_bf16 v[44:47], v[156:159], v[128:131], v[44:47]
    ds_read_b64_tr_b16 v[180:181], v7 offset:32768
    v_mfma_f32_16x16x32_bf16 v[48:51], v[112:115], v[100:103], 0
    ds_read_b64_tr_b16 v[182:183], v7 offset:33792
    v_mfma_f32_16x16x32_bf16 v[48:51], v[144:147], v[132:135], v[48:51]
    ds_read_b128 v[196:199], v2 offset:41216
    v_mfma_f32_16x16x32_bf16 v[52:55], v[116:119], v[100:103], 0
    ds_read_b64_tr_b16 v[212:213], v7 offset:40960
    v_mfma_f32_16x16x32_bf16 v[52:55], v[148:151], v[132:135], v[52:55]
    ds_read_b64_tr_b16 v[214:215], v7 offset:41984
    v_mfma_f32_16x16x32_bf16 v[56:59], v[120:123], v[100:103], 0
    ds_read_b128 v[168:171], v3 offset:32768
    v_mfma_f32_16x16x32_bf16 v[56:59], v[152:155], v[132:135], v[56:59]
    ds_read_b64_tr_b16 v[184:185], v8 offset:32768
    v_mfma_f32_16x16x32_bf16 v[60:63], v[124:127], v[100:103], 0
    ds_read_b64_tr_b16 v[186:187], v8 offset:33792
    v_mfma_f32_16x16x32_bf16 v[60:63], v[156:159], v[132:135], v[60:63]
    ds_read_b128 v[200:203], v3 offset:40960
    v_mfma_f32_16x16x32_bf16 v[64:67], v[112:115], v[104:107], 0
    ds_read_b64_tr_b16 v[216:217], v8 offset:40960
    v_mfma_f32_16x16x32_bf16 v[64:67], v[144:147], v[136:139], v[64:67]
    ds_read_b64_tr_b16 v[218:219], v8 offset:41984
    v_mfma_f32_16x16x32_bf16 v[68:71], v[116:119], v[104:107], 0
    ds_read_b128 v[172:175], v3 offset:33024
    v_mfma_f32_16x16x32_bf16 v[68:71], v[148:151], v[136:139], v[68:71]
    ds_read_b64_tr_b16 v[188:189], v9 offset:32768
    v_mfma_f32_16x16x32_bf16 v[72:75], v[120:123], v[104:107], 0
    ds_read_b64_tr_b16 v[190:191], v9 offset:33792
    v_mfma_f32_16x16x32_bf16 v[72:75], v[152:155], v[136:139], v[72:75]
    ds_read_b128 v[204:207], v3 offset:41216
    v_mfma_f32_16x16x32_bf16 v[76:79], v[124:127], v[104:107], 0
    ds_read_b64_tr_b16 v[220:221], v9 offset:40960
    v_mfma_f32_16x16x32_bf16 v[76:79], v[156:159], v[136:139], v[76:79]
    ds_read_b64_tr_b16 v[222:223], v9 offset:41984
    v_mfma_f32_16x16x32_bf16 v[80:83], v[112:115], v[108:111], 0
    v_mfma_f32_16x16x32_bf16 v[80:83], v[144:147], v[140:143], v[80:83]
    v_mfma_f32_16x16x32_bf16 v[84:87], v[116:119], v[108:111], 0
    v_mfma_f32_16x16x32_bf16 v[84:87], v[148:151], v[140:143], v[84:87]
    v_mfma_f32_16x16x32_bf16 v[88:91], v[120:123], v[108:111], 0
    v_mfma_f32_16x16x32_bf16 v[88:91], v[152:155], v[140:143], v[88:91]
    v_mfma_f32_16x16x32_bf16 v[92:95], v[124:127], v[108:111], 0
    v_mfma_f32_16x16x32_bf16 v[92:95], v[156:159], v[140:143], v[92:95]
    s_waitcnt lgkmcnt(0)
    s_branch L_g2_s2
.p2align 6
L_g2_cloop:
    s_barrier
    v_mfma_f32_16x16x32_bf16 v[32:35], v[176:179], v[160:163], v[32:35]
    ds_read_b128 v[96:99], v2 offset:0
    v_mfma_f32_16x16x32_bf16 v[32:35], v[208:211], v[192:195], v[32:35]
    ds_read_b64_tr_b16 v[112:113], v6 offset:0
    v_mfma_f32_16x16x32_bf16 v[36:39], v[180:183], v[160:163], v[36:39]
    ds_read_b64_tr_b16 v[114:115], v6 offset:1024
    v_mfma_f32_16x16x32_bf16 v[36:39], v[212:215], v[192:195], v[36:39]
    ds_read_b128 v[128:131], v2 offset:8192
    v_mfma_f32_16x16x32_bf16 v[40:43], v[184:187], v[160:163], v[40:43]
    ds_read_b64_tr_b16 v[144:145], v6 offset:8192
    v_mfma_f32_16x16x32_bf16 v[40:43], v[216:219], v[192:195], v[40:43]
    ds_read_b64_tr_b16 v[146:147], v6 offset:9216
    v_mfma_f32_16x16x32_bf16 v[44:47], v[188:191], v[160:163], v[44:47]
    ds_read_b128 v[100:103], v2 offset:256
    v_mfma_f32_16x16x32_bf16 v[44:47], v[220:223], v[192:195], v[44:47]
    ds_read_b64_tr_b16 v[116:117], v7 offset:0
    v_mfma_f32_16x16x32_bf16 v[48:51], v[176:179], v[164:167], v[48:51]
    ds_read_b64_tr_b16 v[118:119], v7 offset:1024
    v_mfma_f32_16x16x32_bf16 v[48:51], v[208:211], v[196:199], v[48:51]
    ds_read_b128 v[132:135], v2 offset:8448
    v_mfma_f32_16x16x32_bf16 v[52:55], v[180:183], v[164:167], v[52:55]
    ds_read_b64_tr_b16 v[148:149], v7 offset:8192
    v_mfma_f32_16x16x32_bf16 v[52:55], v[212:215], v[196:199], v[52:55]
    ds_read_b64_tr_b16 v[150:151], v7 offset:9216
    v_mfma_f32_16x16x32_bf16 v[56:59], v[184:187], v[164:167], v[56:59]
    ds_read_b128 v[104:107], v3 offset:0
    v_mfma_f32_16x16x32_bf16 v[56:59], v[216:219], v[196:199], v[56:59]
    ds_read_b64_tr_b16 v[120:121], v8 offset:0
    v_mfma_f32_16x16x32_bf16 v[60:63], v[188:191], v[164:167], v[60:63]
    ds_read_b64_tr_b16 v[122:123], v8 offset:1024
    v_mfma_f32_16x16x32_bf16 v[60:63], v[220:223], v[196:199], v[60:63]
    ds_read_b128 v[136:139], v3 offset:8192
    v_mfma_f32_16x16x32_bf16 v[64:67], v[176:179], v[168:171], v[64:67]
    ds_read_b64_tr_b16 v[152:153], v8 offset:8192
    v_mfma_f32_16x16x32_bf16 v[64:67], v[208:211], v[200:203], v[64:67]
    ds_read_b64_tr_b16 v[154:155], v8 offset:9216
    v_mfma_f32_16x16x32_bf16 v[68:71], v[180:183], v[168:171], v[68:71]
    ds_read_b128 v[108:111], v3 offset:256
    v_mfma_f32_16x16x32_bf16 v[68:71], v[212:215], v[200:203], v[68:71]
    ds_read_b64_tr_b16 v[124:125], v9 offset:0
    v_mfma_f32_16x16x32_bf16 v[72:75], v[184:187], v[168:171], v[72:75]
    ds_read_b64_tr_b16 v[126:127], v9 offset:1024
    v_mfma_f32_16x16x32_bf16 v[72:75], v[216:219], v[200:203], v[72:75]
    ds_read_b128 v[140:143], v3 offset:8448
    v_mfma_f32_16x16x32_bf16 v[76:79], v[188:191], v[168:171], v[76:79]
    ds_read_b64_tr_b16 v[156:157], v9 offset:8192
    v_mfma_f32_16x16x32_bf16 v[76:79], v[220:223], v[200:203], v[76:79]
    ds_read_b64_tr_b16 v[158:159], v9 offset:9216
    v_mfma_f32_16x16x32_bf16 v[80:83], v[176:179], v[172:175], v[80:83]
    v_mfma_f32_16x16x32_bf16 v[80:83], v[208:211], v[204:207], v[80:83]
    v_mfma_f32_16x16x32_bf16 v[84:87], v[180:183], v[172:175], v[84:87]
    v_mfma_f32_16x16x32_bf16 v[84:87], v[212:215], v[204:207], v[84:87]
    v_mfma_f32_16x16x32_bf16 v[88:91], v[184:187], v[172:175], v[88:91]
    v_mfma_f32_16x16x32_bf16 v[88:91], v[216:219], v[204:207], v[88:91]
    v_mfma_f32_16x16x32_bf16 v[92:95], v[188:191], v[172:175], v[92:95]
    v_mfma_f32_16x16x32_bf16 v[92:95], v[220:223], v[204:207], v[92:95]
    s_waitcnt lgkmcnt(0)
    s_barrier
    v_mfma_f32_16x16x32_bf16 v[32:35], v[112:115], v[96:99], v[32:35]
    ds_read_b128 v[160:163], v2 offset:32768
    v_mfma_f32_16x16x32_bf16 v[32:35], v[144:147], v[128:131], v[32:35]
    ds_read_b64_tr_b16 v[176:177], v6 offset:32768
    v_mfma_f32_16x16x32_bf16 v[36:39], v[116:119], v[96:99], v[36:39]
    ds_read_b64_tr_b16 v[178:179], v6 offset:33792
    v_mfma_f32_16x16x32_bf16 v[36:39], v[148:151], v[128:131], v[36:39]
    ds_read_b128 v[192:195], v2 offset:40960
    v_mfma_f32_16x16x32_bf16 v[40:43], v[120:123], v[96:99], v[40:43]
    ds_read_b64_tr_b16 v[208:209], v6 offset:40960
    v_mfma_f32_16x16x32_bf16 v[40:43], v[152:155], v[128:131], v[40:43]
    ds_read_b64_tr_b16 v[210:211], v6 offset:41984
    v_mfma_f32_16x16x32_bf16 v[44:47], v[124:127], v[96:99], v[44:47]
    ds_read_b128 v[164:167], v2 offset:33024
    v_mfma_f32_16x16x32_bf16 v[44:47], v[156:159], v[128:131], v[44:47]
    ds_read_b64_tr_b16 v[180:181], v7 offset:32768
    v_mfma_f32_16x16x32_bf16 v[48:51], v[112:115], v[100:103], v[48:51]
    ds_read_b64_tr_b16 v[182:183], v7 offset:33792
    v_mfma_f32_16x16x32_bf16 v[48:51], v[144:147], v[132:135], v[48:51]
    ds_read_b128 v[196:199], v2 offset:41216
    v_mfma_f32_16x16x32_bf16 v[52:55], v[116:119], v[100:103], v[52:55]
    ds_read_b64_tr_b16 v[212:213], v7 offset:40960
    v_mfma_f32_16x16x32_bf16 v[52:55], v[148:151], v[132:135], v[52:55]
    ds_read_b64_tr_b16 v[214:215], v7 offset:41984
    v_mfma_f32_16x16x32_bf16 v[56:59], v[120:123], v[100:103], v[56:59]
    ds_read_b128 v[168:171], v3 offset:32768
    v_mfma_f32_16x16x32_bf16 v[56:59], v[152:155], v[132:135], v[56:59]
    ds_read_b64_tr_b16 v[184:185], v8 offset:32768
    v_mfma_f32_16x16x32_bf16 v[60:63], v[124:127], v[100:103], v[60:63]
    ds_read_b64_tr_b16 v[186:187], v8 offset:33792
    v_mfma_f32_16x16x32_bf16 v[60:63], v[156:159], v[132:135], v[60:63]
    ds_read_b128 v[200:203], v3 offset:40960
    v_mfma_f32_16x16x32_bf16 v[64:67], v[112:115], v[104:107], v[64:67]
    ds_read_b64_tr_b16 v[216:217], v8 offset:40960
    v_mfma_f32_16x16x32_bf16 v[64:67], v[144:147], v[136:139], v[64:67]
    ds_read_b64_tr_b16 v[218:219], v8 offset:41984
    v_mfma_f32_16x16x32_bf16 v[68:71], v[116:119], v[104:107], v[68:71]
    ds_read_b128 v[172:175], v3 offset:33024
    v_mfma_f32_16x16x32_bf16 v[68:71], v[148:151], v[136:139], v[68:71]
    ds_read_b64_tr_b16 v[188:189], v9 offset:32768
    v_mfma_f32_16x16x32_bf16 v[72:75], v[120:123], v[104:107], v[72:75]
    ds_read_b64_tr_b16 v[190:191], v9 offset:33792
    v_mfma_f32_16x16x32_bf16 v[72:75], v[152:155], v[136:139], v[72:75]
    ds_read_b128 v[204:207], v3 offset:41216
    v_mfma_f32_16x16x32_bf16 v[76:79], v[124:127], v[104:107], v[76:79]
    ds_read_b64_tr_b16 v[220:221], v9 offset:40960
    v_mfma_f32_16x16x32_bf16 v[76:79], v[156:159], v[136:139], v[76:79]
    ds_read_b64_tr_b16 v[222:223], v9 offset:41984
    v_mfma_f32_16x16x32_bf16 v[80:83], v[112:115], v[108:111], v[80:83]
    v_mfma_f32_16x16x32_bf16 v[80:83], v[144:147], v[140:143], v[80:83]
    v_mfma_f32_16x16x32_bf16 v[84:87], v[116:119], v[108:111], v[84:87]
    v_mfma_f32_16x16x32_bf16 v[84:87], v[148:151], v[140:143], v[84:87]
    v_mfma_f32_16x16x32_bf16 v[88:91], v[120:123], v[108:111], v[88:91]
    v_mfma_f32_16x16x32_bf16 v[88:91], v[152:155], v[140:143], v[88:91]
    v_mfma_f32_16x16x32_bf16 v[92:95], v[124:127], v[108:111], v[92:95]
    v_mfma_f32_16x16x32_bf16 v[92:95], v[156:159], v[140:143], v[92:95]
    s_waitcnt lgkmcnt(0)
L_g2_s2:
    s_barrier
    v_mfma_f32_16x16x32_bf16 v[32:35], v[176:179], v[160:163], v[32:35]
    ds_read_b128 v[96:99], v4 offset:0
    v_mfma_f32_16x16x32_bf16 v[32:35], v[208:211], v[192:195], v[32:35]
    ds_read_b64_tr_b16 v[112:113], v10 offset:0
    v_mfma_f32_16x16x32_bf16 v[36:39], v[180:183], v[160:163], v[36:39]
    ds_read_b64_tr_b16 v[114:115], v10 offset:1024
    v_mfma_f32_16x16x32_bf16 v[36:39], v[212:215], v[192:195], v[36:39]
    ds_read_b128 v[128:131], v4 offset:8192
    v_mfma_f32_16x16x32_bf16 v[40:43], v[184:187], v[160:163], v[40:43]
    ds_read_b64_tr_b16 v[144:145], v10 offset:8192
    v_mfma_f32_16x16x32_bf16 v[40:43], v[216:219], v[192:195], v[40:43]
    ds_read_b64_tr_b16 v[146:147], v10 offset:9216
    v_mfma_f32_16x16x32_bf16 v[44:47], v[188:191], v[160:163], v[44:47]
    ds_read_b128 v[100:103], v4 offset:256
    v_mfma_f32_16x16x32_bf16 v[44:47], v[220:223], v[192:195], v[44:47]
    ds_read_b64_tr_b16 v[116:117], v11 offset:0
    v_mfma_f32_16x16x32_bf16 v[48:51], v[176:179], v[164:167], v[48:51]
    ds_read_b64_tr_b16 v[118:119], v11 offset:1024
    v_mfma_f32_16x16x32_bf16 v[48:51], v[208:211], v[196:199], v[48:51]
    ds_read_b128 v[132:135], v4 offset:8448
    v_mfma_f32_16x16x32_bf16 v[52:55], v[180:183], v[164:167], v[52:55]
    ds_read_b64_tr_b16 v[148:149], v11 offset:8192
    v_mfma_f32_16x16x32_bf16 v[52:55], v[212:215], v[196:199], v[52:55]
    ds_read_b64_tr_b16 v[150:151], v11 offset:9216
    v_mfma_f32_16x16x32_bf16 v[56:59], v[184:187], v[164:167], v[56:59]
    ds_read_b128 v[104:107], v5 offset:0
    v_mfma_f32_16x16x32_bf16 v[56:59], v[216:219], v[196:199], v[56:59]
    ds_read_b64_tr_b16 v[120:121], v12 offset:0
    v_mfma_f32_16x16x32_bf16 v[60:63], v[188:191], v[164:167], v[60:63]
    ds_read_b64_tr_b16 v[122:123], v12 offset:1024
    v_mfma_f32_16x16x32_bf16 v[60:63], v[220:223], v[196:199], v[60:63]
    ds_read_b128 v[136:139], v5 offset:8192
    v_mfma_f32_16x16x32_bf16 v[64:67], v[176:179], v[168:171], v[64:67]
    ds_read_b64_tr_b16 v[152:153], v12 offset:8192
    v_mfma_f32_16x16x32_bf16 v[64:67], v[208:211], v[200:203], v[64:67]
    ds_read_b64_tr_b16 v[154:155], v12 offset:9216
    v_mfma_f32_16x16x32_bf16 v[68:71], v[180:183], v[168:171], v[68:71]
    ds_read_b128 v[108:111], v5 offset:256
    v_mfma_f32_16x16x32_bf16 v[68:71], v[212:215], v[200:203], v[68:71]
    ds_read_b64_tr_b16 v[124:125], v13 offset:0
    v_mfma_f32_16x16x32_bf16 v[72:75], v[184:187], v[168:171], v[72:75]
    ds_read_b64_tr_b16 v[126:127], v13 offset:1024
    v_mfma_f32_16x16x32_bf16 v[72:75], v[216:219], v[200:203], v[72:75]
    ds_read_b128 v[140:143], v5 offset:8448
    v_mfma_f32_16x16x32_bf16 v[76:79], v[188:191], v[168:171], v[76:79]
    ds_read_b64_tr_b16 v[156:157], v13 offset:8192
    v_mfma_f32_16x16x32_bf16 v[76:79], v[220:223], v[200:203], v[76:79]
    ds_read_b64_tr_b16 v[158:159], v13 offset:9216
    v_mfma_f32_16x16x32_bf16 v[80:83], v[176:179], v[172:175], v[80:83]
    v_mfma_f32_16x16x32_bf16 v[80:83], v[208:211], v[204:207], v[80:83]
    v_mfma_f32_16x16x32_bf16 v[84:87], v[180:183], v[172:175], v[84:87]
    v_mfma_f32_16x16x32_bf16 v[84:87], v[212:215], v[204:207], v[84:87]
    v_mfma_f32_16x16x32_bf16 v[88:91], v[184:187], v[172:175], v[88:91]
    v_mfma_f32_16x16x32_bf16 v[88:91], v[216:219], v[204:207], v[88:91]
    v_mfma_f32_16x16x32_bf16 v[92:95], v[188:191], v[172:175], v[92:95]
    v_mfma_f32_16x16x32_bf16 v[92:95], v[220:223], v[204:207], v[92:95]
    s_cmp_eq_u32 s46, 5
    s_cbranch_scc0 L_g2_nores
    buffer_load_dwordx2 v[224:225], v20, s[20:23], s64 offen offset:0 sc1
    buffer_load_dwordx2 v[226:227], v20, s[20:23], s65 offen offset:0 sc1
    buffer_load_dwordx2 v[228:229], v20, s[20:23], s66 offen offset:0 sc1
    buffer_load_dwordx2 v[230:231], v20, s[20:23], s67 offen offset:0 sc1
    buffer_load_dwordx2 v[232:233], v20, s[20:23], s64 offen offset:128 sc1
    buffer_load_dwordx2 v[234:235], v20, s[20:23], s65 offen offset:128 sc1
    buffer_load_dwordx2 v[236:237], v20, s[20:23], s66 offen offset:128 sc1
    buffer_load_dwordx2 v[238:239], v20, s[20:23], s67 offen offset:128 sc1
L_g2_nores:
    s_waitcnt lgkmcnt(0)
    s_barrier
    v_mfma_f32_16x16x32_bf16 v[32:35], v[112:115], v[96:99], v[32:35]
    ds_read_b128 v[160:163], v4 offset:32768
    v_mfma_f32_16x16x32_bf16 v[32:35], v[144:147], v[128:131], v[32:35]
    ds_read_b64_tr_b16 v[176:177], v10 offset:32768
    v_mfma_f32_16x16x32_bf16 v[36:39], v[116:119], v[96:99], v[36:39]
    ds_read_b64_tr_b16 v[178:179], v10 offset:33792
    v_mfma_f32_16x16x32_bf16 v[36:39], v[148:151], v[128:131], v[36:39]
    ds_read_b128 v[192:195], v4 offset:40960
    v_mfma_f32_16x16x32_bf16 v[40:43], v[120:123], v[96:99], v[40:43]
    ds_read_b64_tr_b16 v[208:209], v10 offset:40960
    v_mfma_f32_16x16x32_bf16 v[40:43], v[152:155], v[128:131], v[40:43]
    ds_read_b64_tr_b16 v[210:211], v10 offset:41984
    v_mfma_f32_16x16x32_bf16 v[44:47], v[124:127], v[96:99], v[44:47]
    ds_read_b128 v[164:167], v4 offset:33024
    v_mfma_f32_16x16x32_bf16 v[44:47], v[156:159], v[128:131], v[44:47]
    ds_read_b64_tr_b16 v[180:181], v11 offset:32768
    v_mfma_f32_16x16x32_bf16 v[48:51], v[112:115], v[100:103], v[48:51]
    ds_read_b64_tr_b16 v[182:183], v11 offset:33792
    v_mfma_f32_16x16x32_bf16 v[48:51], v[144:147], v[132:135], v[48:51]
    ds_read_b128 v[196:199], v4 offset:41216
    v_mfma_f32_16x16x32_bf16 v[52:55], v[116:119], v[100:103], v[52:55]
    ds_read_b64_tr_b16 v[212:213], v11 offset:40960
    v_mfma_f32_16x16x32_bf16 v[52:55], v[148:151], v[132:135], v[52:55]
    ds_read_b64_tr_b16 v[214:215], v11 offset:41984
    v_mfma_f32_16x16x32_bf16 v[56:59], v[120:123], v[100:103], v[56:59]
    ds_read_b128 v[168:171], v5 offset:32768
    v_mfma_f32_16x16x32_bf16 v[56:59], v[152:155], v[132:135], v[56:59]
    ds_read_b64_tr_b16 v[184:185], v12 offset:32768
    v_mfma_f32_16x16x32_bf16 v[60:63], v[124:127], v[100:103], v[60:63]
    ds_read_b64_tr_b16 v[186:187], v12 offset:33792
    v_mfma_f32_16x16x32_bf16 v[60:63], v[156:159], v[132:135], v[60:63]
    ds_read_b128 v[200:203], v5 offset:40960
    v_mfma_f32_16x16x32_bf16 v[64:67], v[112:115], v[104:107], v[64:67]
    ds_read_b64_tr_b16 v[216:217], v12 offset:40960
    v_mfma_f32_16x16x32_bf16 v[64:67], v[144:147], v[136:139], v[64:67]
    ds_read_b64_tr_b16 v[218:219], v12 offset:41984
    v_mfma_f32_16x16x32_bf16 v[68:71], v[116:119], v[104:107], v[68:71]
    ds_read_b128 v[172:175], v5 offset:33024
    v_mfma_f32_16x16x32_bf16 v[68:71], v[148:151], v[136:139], v[68:71]
    ds_read_b64_tr_b16 v[188:189], v13 offset:32768
    v_mfma_f32_16x16x32_bf16 v[72:75], v[120:123], v[104:107], v[72:75]
    ds_read_b64_tr_b16 v[190:191], v13 offset:33792
    v_mfma_f32_16x16x32_bf16 v[72:75], v[152:155], v[136:139], v[72:75]
    ds_read_b128 v[204:207], v5 offset:41216
    v_mfma_f32_16x16x32_bf16 v[76:79], v[124:127], v[104:107], v[76:79]
    ds_read_b64_tr_b16 v[220:221], v13 offset:40960
    v_mfma_f32_16x16x32_bf16 v[76:79], v[156:159], v[136:139], v[76:79]
    ds_read_b64_tr_b16 v[222:223], v13 offset:41984
    v_mfma_f32_16x16x32_bf16 v[80:83], v[112:115], v[108:111], v[80:83]
    v_mfma_f32_16x16x32_bf16 v[80:83], v[144:147], v[140:143], v[80:83]
    v_mfma_f32_16x16x32_bf16 v[84:87], v[116:119], v[108:111], v[84:87]
    v_mfma_f32_16x16x32_bf16 v[84:87], v[148:151], v[140:143], v[84:87]
    v_mfma_f32_16x16x32_bf16 v[88:91], v[120:123], v[108:111], v[88:91]
    v_mfma_f32_16x16x32_bf16 v[88:91], v[152:155], v[140:143], v[88:91]
    v_mfma_f32_16x16x32_bf16 v[92:95], v[124:127], v[108:111], v[92:95]
    v_mfma_f32_16x16x32_bf16 v[92:95], v[156:159], v[140:143], v[92:95]
    s_add_u32 s46, s46, 1
    s_cmp_lt_u32 s46, 7
    s_waitcnt lgkmcnt(0)
    s_cbranch_scc1 L_g2_cloop
    s_lshl_b32 s35, s51, 12
    s_lshl_b32 s37, s50, 12
    v_mfma_f32_16x16x32_bf16 v[64:67], v[176:179], v[168:171], v[64:67]
    v_mfma_f32_16x16x32_bf16 v[64:67], v[208:211], v[200:203], v[64:67]
    v_mfma_f32_16x16x32_bf16 v[68:71], v[180:183], v[168:171], v[68:71]
    v_mfma_f32_16x16x32_bf16 v[68:71], v[212:215], v[200:203], v[68:71]
    v_mfma_f32_16x16x32_bf16 v[72:75], v[184:187], v[168:171], v[72:75]
    v_mfma_f32_16x16x32_bf16 v[72:75], v[216:219], v[200:203], v[72:75]
    v_mfma_f32_16x16x32_bf16 v[76:79], v[188:191], v[168:171], v[76:79]
    v_mfma_f32_16x16x32_bf16 v[76:79], v[220:223], v[200:203], v[76:79]
    v_mfma_f32_16x16x32_bf16 v[80:83], v[176:179], v[172:175], v[80:83]
    v_mfma_f32_16x16x32_bf16 v[80:83], v[208:211], v[204:207], v[80:83]
    v_mfma_f32_16x16x32_bf16 v[84:87], v[180:183], v[172:175], v[84:87]
    v_mfma_f32_16x16x32_bf16 v[84:87], v[212:215], v[204:207], v[84:87]
    v_mfma_f32_16x16x32_bf16 v[88:91], v[184:187], v[172:175], v[88:91]
    v_mfma_f32_16x16x32_bf16 v[88:91], v[216:219], v[204:207], v[88:91]
    v_mfma_f32_16x16x32_bf16 v[92:95], v[188:191], v[172:175], v[92:95]
    v_mfma_f32_16x16x32_bf16 v[92:95], v[220:223], v[204:207], v[92:95]
    v_mfma_f32_16x16x32_bf16 v[32:35], v[176:179], v[160:163], v[32:35]
    v_mfma_f32_16x16x32_bf16 v[32:35], v[208:211], v[192:195], v[32:35]
    v_mfma_f32_16x16x32_bf16 v[36:39], v[180:183], v[160:163], v[36:39]
    v_mfma_f32_16x16x32_bf16 v[36:39], v[212:215], v[192:195], v[36:39]
    v_mfma_f32_16x16x32_bf16 v[40:43], v[184:187], v[160:163], v[40:43]
    v_cvt_pk_bf16_f32 v96, v64, v65
    v_cvt_pk_bf16_f32 v97, v66, v67
    v_mfma_f32_16x16x32_bf16 v[40:43], v[216:219], v[192:195], v[40:43]
    v_cvt_pk_bf16_f32 v98, v68, v69
    v_cvt_pk_bf16_f32 v99, v70, v71
    v_mfma_f32_16x16x32_bf16 v[44:47], v[188:191], v[160:163], v[44:47]
    buffer_store_dwordx4 v[96:99], v22, s[52:55], s35 offen offset:0 sc1
    v_cvt_pk_bf16_f32 v100, v72, v73
    v_mfma_f32_16x16x32_bf16 v[44:47], v[220:223], v[192:195], v[44:47]
    v_cvt_pk_bf16_f32 v101, v74, v75
    v_cvt_pk_bf16_f32 v102, v76, v77
    v_mfma_f32_16x16x32_bf16 v[48:51], v[176:179], v[164:167], v[48:51]
    v_cvt_pk_bf16_f32 v103, v78, v79
    buffer_store_dwordx4 v[100:103], v22, s[52:55], s35 offen offset:1024 sc1
    v_mfma_f32_16x16x32_bf16 v[48:51], v[208:211], v[196:199], v[48:51]
    v_cvt_pk_bf16_f32 v104, v80, v81
    v_cvt_pk_bf16_f32 v105, v82, v83
    v_mfma_f32_16x16x32_bf16 v[52:55], v[180:183], v[164:167], v[52:55]
    v_cvt_pk_bf16_f32 v106, v84, v85
    v_cvt_pk_bf16_f32 v107, v86, v87
    v_mfma_f32_16x16x32_bf16 v[52:55], v[212:215], v[196:199], v[52:55]
    buffer_store_dwordx4 v[104:107], v22, s[52:55], s35 offen offset:2048 sc1
    v_cvt_pk_bf16_f32 v108, v88, v89
    v_mfma_f32_16x16x32_bf16 v[56:59], v[184:187], v[164:167], v[56:59]
    v_cvt_pk_bf16_f32 v109, v90, v91
    v_cvt_pk_bf16_f32 v110, v92, v93
    v_mfma_f32_16x16x32_bf16 v[56:59], v[216:219], v[196:199], v[56:59]
    v_cvt_pk_bf16_f32 v111, v94, v95
    buffer_store_dwordx4 v[108:111], v22, s[52:55], s35 offen offset:3072 sc1
    v_mfma_f32_16x16x32_bf16 v[60:63], v[188:191], v[164:167], v[60:63]
    v_mfma_f32_16x16x32_bf16 v[60:63], v[220:223], v[196:199], v[60:63]
    s_mov_b32 s47, 0xffff0000
    s_waitcnt vmcnt(4)
    v_lshlrev_b32 v26, 16, v224
    v_and_b32 v27, s47, v224
    v_pk_add_f32 v[32:33], v[32:33], v[26:27]
    v_lshlrev_b32 v28, 16, v225
    v_and_b32 v29, s47, v225
    v_pk_add_f32 v[34:35], v[34:35], v[28:29]
    v_lshlrev_b32 v26, 16, v226
    v_and_b32 v27, s47, v226
    v_pk_add_f32 v[36:37], v[36:37], v[26:27]
    v_lshlrev_b32 v28, 16, v227
    v_and_b32 v29, s47, v227
    v_pk_add_f32 v[38:39], v[38:39], v[28:29]
    v_lshlrev_b32 v26, 16, v228
    v_and_b32 v27, s47, v228
    v_pk_add_f32 v[40:41], v[40:41], v[26:27]
    v_lshlrev_b32 v28, 16, v229
    v_and_b32 v29, s47, v229
    v_pk_add_f32 v[42:43], v[42:43], v[28:29]
    v_lshlrev_b32 v26, 16, v230
    v_and_b32 v27, s47, v230
    v_pk_add_f32 v[44:45], v[44:45], v[26:27]
    v_lshlrev_b32 v28, 16, v231
    v_and_b32 v29, s47, v231
    v_pk_add_f32 v[46:47], v[46:47], v[28:29]
    v_lshlrev_b32 v26, 16, v232
    v_and_b32 v27, s47, v232
    v_pk_add_f32 v[48:49], v[48:49], v[26:27]
    v_lshlrev_b32 v28, 16, v233
    v_and_b32 v29, s47, v233
    v_pk_add_f32 v[50:51], v[50:51], v[28:29]
    v_lshlrev_b32 v26, 16, v234
    v_and_b32 v27, s47, v234
    v_pk_add_f32 v[52:53], v[52:53], v[26:27]
    v_lshlrev_b32 v28, 16, v235
    v_and_b32 v29, s47, v235
    v_pk_add_f32 v[54:55], v[54:55], v[28:29]
    s_nop 0
    v_lshlrev_b32 v26, 16, v236
    v_and_b32 v27, s47, v236
    v_pk_add_f32 v[56:57], v[56:57], v[26:27]
    v_lshlrev_b32 v28, 16, v237
    v_and_b32 v29, s47, v237
    v_pk_add_f32 v[58:59], v[58:59], v[28:29]
    v_lshlrev_b32 v26, 16, v238
    v_and_b32 v27, s47, v238
    v_pk_add_f32 v[60:61], v[60:61], v[26:27]
    v_lshlrev_b32 v28, 16, v239
    v_and_b32 v29, s47, v239
    v_pk_add_f32 v[62:63], v[62:63], v[28:29]
    s_mul_i32 s35, s30, 4608
    s_add_u32 s35, s35, 131072
    v_mul_u32_u24 v30, 144, v17
    v_lshl_add_u32 v30, v15, 3, v30
    v_add_u32 v30, s35, v30
    v_lshrrev_b32 v18, 3, v14
    v_and_b32 v19, 7, v14
    v_mul_u32_u24 v31, 144, v18
    v_lshl_add_u32 v31, v19, 4, v31
    v_add_u32 v31, s35, v31
    s_lshl_b32 s35, s33, 7
    s_lshl_b32 s36, s38, 6
    s_add_u32 s35, s35, s36
    s_lshl_b32 s36, s29, 5
    s_add_u32 s35, s35, s36
    v_add_u32 v18, s35, v18
    v_lshlrev_b32 v21, 11, v18
    v_lshl_add_u32 v21, v19, 4, v21
    s_lshl_b32 s35, s34, 8
    s_lshl_b32 s36, s39, 7
    s_add_u32 s35, s35, s36
    v_add_u32 v21, s35, v21
    s_mov_b32 s48, 0
L_g2_poll:
    buffer_load_dwordx4 v[112:115], v22, s[52:55], s37 offen offset:0 sc1
    buffer_load_dwordx4 v[116:119], v22, s[52:55], s37 offen offset:1024 sc1
    buffer_load_dwordx4 v[120:123], v22, s[52:55], s37 offen offset:2048 sc1
    buffer_load_dwordx4 v[124:127], v22, s[52:55], s37 offen offset:3072 sc1
    s_add_u32 s48, s48, 1
    s_waitcnt vmcnt(3)
    v_max3_u32 v23, v112, v113, v114
    v_max3_u32 v23, v115, v115, v23
    s_waitcnt vmcnt(2)
    v_max3_u32 v24, v116, v117, v118
    v_max3_u32 v24, v119, v119, v24
    s_waitcnt vmcnt(1)
    v_max3_u32 v23, v120, v121, v23
    v_max3_u32 v23, v123, v122, v23
    s_waitcnt vmcnt(0)
    v_max3_u32 v24, v124, v125, v24
    v_max3_u32 v24, v127, v126, v24
    v_max_u32 v23, v23, v24
    v_cmp_eq_u32 vcc, -1, v23
    s_cmp_ge_u32 s48, 0x80000
    s_cbranch_vccz L_g2_got
    s_cbranch_scc0 L_g2_poll
L_g2_got:
    v_lshlrev_b32 v26, 16, v112
    v_and_b32 v27, s47, v112
    v_pk_add_f32 v[32:33], v[32:33], v[26:27]
    v_cvt_pk_bf16_f32 v160, v32, v33
    v_lshlrev_b32 v28, 16, v113
    v_and_b32 v29, s47, v113
    v_pk_add_f32 v[34:35], v[34:35], v[28:29]
    v_cvt_pk_bf16_f32 v161, v34, v35
    v_lshlrev_b32 v26, 16, v114
    v_and_b32 v27, s47, v114
    v_pk_add_f32 v[36:37], v[36:37], v[26:27]
    v_cvt_pk_bf16_f32 v162, v36, v37
    v_lshlrev_b32 v28, 16, v115
    v_and_b32 v29, s47, v115
    v_pk_add_f32 v[38:39], v[38:39], v[28:29]
    v_cvt_pk_bf16_f32 v163, v38, v39
    ds_write_b64 v30, v[160:161] offset:0
    ds_write_b64 v30, v[162:163] offset:32
    v_lshlrev_b32 v26, 16, v116
    v_and_b32 v27, s47, v116
    v_pk_add_f32 v[40:41], v[40:41], v[26:27]
    v_cvt_pk_bf16_f32 v164, v40, v41
    v_lshlrev_b32 v28, 16, v117
    v_and_b32 v29, s47, v117
    v_pk_add_f32 v[42:43], v[42:43], v[28:29]
    v_cvt_pk_bf16_f32 v165, v42, v43
    v_lshlrev_b32 v26, 16, v118
    v_and_b32 v27, s47, v118
    v_pk_add_f32 v[44:45], v[44:45], v[26:27]
    v_cvt_pk_bf16_f32 v166, v44, v45
    v_lshlrev_b32 v28, 16, v119
    v_and_b32 v29, s47, v119
    v_pk_add_f32 v[46:47], v[46:47], v[28:29]
    v_cvt_pk_bf16_f32 v167, v46, v47
    ds_write_b64 v30, v[164:165] offset:64
    ds_write_b64 v30, v[166:167] offset:96
    v_lshlrev_b32 v26, 16, v120
    v_and_b32 v27, s47, v120
    v_pk_add_f32 v[48:49], v[48:49], v[26:27]
    v_cvt_pk_bf16_f32 v168, v48, v49
    v_lshlrev_b32 v28, 16, v121
    v_and_b32 v29, s47, v121
    v_pk_add_f32 v[50:51], v[50:51], v[28:29]
    v_cvt_pk_bf16_f32 v169, v50, v51
    v_lshlrev_b32 v26, 16, v122
    v_and_b32 v27, s47, v122
    v_pk_add_f32 v[52:53], v[52:53], v[26:27]
    v_cvt_pk_bf16_f32 v170, v52, v53
    v_lshlrev_b32 v28, 16, v123
    v_and_b32 v29, s47, v123
    v_pk_add_f32 v[54:55], v[54:55], v[28:29]
    v_cvt_pk_bf16_f32 v171, v54, v55
    ds_write_b64 v30, v[168:169] offset:2304
    ds_write_b64 v30, v[170:171] offset:2336
    v_lshlrev_b32 v26, 16, v124
    v_and_b32 v27, s47, v124
    v_pk_add_f32 v[56:57], v[56:57], v[26:27]
    v_cvt_pk_bf16_f32 v172, v56, v57
    v_lshlrev_b32 v28, 16, v125
    v_and_b32 v29, s47, v125
    v_pk_add_f32 v[58:59], v[58:59], v[28:29]
    v_cvt_pk_bf16_f32 v173, v58, v59
    v_lshlrev_b32 v26, 16, v126
    v_and_b32 v27, s47, v126
    v_pk_add_f32 v[60:61], v[60:61], v[26:27]
    v_cvt_pk_bf16_f32 v174, v60, v61
    v_lshlrev_b32 v28, 16, v127
    v_and_b32 v29, s47, v127
    v_pk_add_f32 v[62:63], v[62:63], v[28:29]
    v_cvt_pk_bf16_f32 v175, v62, v63
    ds_write_b64 v30, v[172:173] offset:2368
    ds_write_b64 v30, v[174:175] offset:2400
    s_waitcnt lgkmcnt(0)
    ds_read_b128 v[176:179], v31 offset:0
    ds_read_b128 v[180:183], v31 offset:1152
    ds_read_b128 v[184:187], v31 offset:2304
    ds_read_b128 v[188:191], v31 offset:3456
    s_mov_b32 s48, 0
    s_waitcnt lgkmcnt(3)
    buffer_store_dwordx4 v[176:179], v21, s[24:27], s48 offen sc1
    s_mov_b32 s48, 16384
    s_waitcnt lgkmcnt(2)
    buffer_store_dwordx4 v[180:183], v21, s[24:27], s48 offen sc1
    s_mov_b32 s48, 32768
    s_waitcnt lgkmcnt(1)
    buffer_store_dwordx4 v[184:187], v21, s[24:27], s48 offen sc1
    s_mov_b32 s48, 49152
    s_waitcnt lgkmcnt(0)
    buffer_store_dwordx4 v[188:191], v21, s[24:27], s48 offen sc1
L_g2_end:
    s_endpgm

code_end:
    s_endpgm
.section .rodata,"a"
.p2align 6
.amdhsa_kernel sequential_preLN__ssm_conv_s4d__geglu_ffn__prompt_kernel
  .amdhsa_next_free_vgpr 256
  .amdhsa_next_free_sgpr 100
  .amdhsa_accum_offset 256
  .amdhsa_group_segment_fixed_size 0
  .amdhsa_kernarg_size 112
  .amdhsa_user_sgpr_count 2
  .amdhsa_user_sgpr_kernarg_segment_ptr 1
  .amdhsa_system_sgpr_workgroup_id_x 1
.end_amdhsa_kernel
```
